```python
import torch

def _softmax(x, axis=-1):
    return torch.softmax(x, dim=axis)
def _gelu(x):
    return torch.nn.functional.gelu(x, approximate="tanh")
def _silu(x):
    return torch.nn.functional.silu(x)
def _sigmoid(x):
    return torch.sigmoid(x)
def _layernorm(x, axis=-1, eps=1e-5):
    m = x.mean(dim=axis, keepdim=True)
    v = x.var(dim=axis, keepdim=True, unbiased=False)
    return (x - m) / torch.sqrt(v + eps)
def _scatter_add(tgt, idx, src, axis=0):
    return tgt.clone().index_add_(axis, idx, src)
def _segment_sum(src, seg, n):
    out = torch.zeros((n,) + src.shape[1:], dtype=src.dtype)
    return out.index_add_(0, seg, src)
def _pad(x, pw):
    flat = tuple(v for pair in reversed(pw) for v in pair)
    return torch.nn.functional.pad(x, flat)

kernel_name = 'standalone__cheap_equivariant_egnn__graph'

def setup_inputs():

    _w = (lambda a: (lambda t: t.to(torch.bfloat16) if t.is_floating_point() else t)(torch.as_tensor(a)))
    N, deg, D, De = 12500, 64, 64, max(16, 1)
    E = N * deg
    return {
        "h": _w((lambda *s: torch.randn(*s, dtype=torch.bfloat16) * 0.1)(N, D)),
        "pos": _w((lambda *s: torch.randn(*s, dtype=torch.bfloat16) * 0.8)(N, 3)),
        "e_attr": _w((lambda *s: torch.randn(*s, dtype=torch.bfloat16) * 0.8)(E, De)),
        "src": _w((lambda lo, hi, *s: torch.randint(lo, hi, s))(0, N, E).to(torch.int64)),
        "dst": _w((lambda lo, hi, *s: torch.randint(lo, hi, s))(0, N, E).to(torch.int64)),
        "w_e": _w(0.1 * (lambda *s: torch.randn(*s, dtype=torch.bfloat16) * 0.8)(2 * D + 1 + De, D)),
        "w_x": _w(0.1 * (lambda *s: torch.randn(*s, dtype=torch.bfloat16) * 0.1)(D, 1)),
        "w_h": _w(0.1 * (lambda *s: torch.randn(*s, dtype=torch.bfloat16) * 0.1)(2 * D, D)),
    }

def reference(h, pos, e_attr, src, dst, w_e, w_x, w_h):
    N, D = h.shape[0], h.shape[1]
    diff = pos[dst] - pos[src]
    dist2 = torch.sum(diff * diff, axis=-1, keepdims=True)
    e_in = torch.concatenate([h[dst], h[src], dist2, e_attr], axis=-1)
    m_ij = _silu(e_in @ w_e)
    coord_scale = m_ij @ w_x
    pos_new = pos + _segment_sum(diff * coord_scale, dst, N)
    m_i = _segment_sum(m_ij, dst, N)
    h_new = h + _silu(torch.concatenate([h, m_i], axis=-1) @ w_h)
    return h_new, pos_new
```

```asm
; @launch grid=(256,1,1) block=(512,1,1) lds=163456
.amdgcn_target "amdgcn-amd-amdhsa--gfx950"
.text
.globl standalone__cheap_equivariant_egnn__graph_kernel
.p2align 8
.type standalone__cheap_equivariant_egnn__graph_kernel,@function
standalone__cheap_equivariant_egnn__graph_kernel:
    s_cmp_ge_u32 s2, 256
    s_cbranch_scc1 K_END
    s_load_dwordx16 s[4:19], s[0:1], 0
    s_load_dwordx2 s[32:33], s[0:1], 80
    s_load_dwordx2 s[44:45], s[0:1], 64
    s_getpc_b64 s[96:97]
K_PC:
    s_lshr_b32 s91, s2, 3
    s_sub_u32 s91, s91, 992
    v_lshl_add_u32 v1, v0, 5, s91
    v_max_i32 v1, v1, v0
    v_cmp_ge_u32 vcc, (K_STUB-K_PC)/128, v1
    v_lshlrev_b32 v239, 7, v1
    s_mov_b64 exec, vcc
    global_load_dword v239, v239, s[96:97]
    s_mov_b64 exec, -1
    v_lshrrev_b32 v1, 6, v0
    v_lshlrev_b32 v249, 4, v0
    v_readfirstlane_b32 s3, v1
    v_cmp_gt_u32 vcc, 288, v0
    v_mov_b32 v68, 0
    v_mov_b32 v69, 0
    v_mov_b32 v70, 0
    v_mov_b32 v71, 0
    v_and_b32 v0, 63, v0
    v_lshlrev_b32 v248, 4, v0
    v_add_u32 v2, 162432, v248
    v_lshrrev_b32 v3, 2, v249
    s_cmp_lt_u32 s2, 250
    s_cselect_b64 s[52:53], -1, 0
    s_and_b64 s[54:55], s[52:53], vcc
    s_mul_i32 s60, s2, 12800
    s_add_u32 s91, s60, 8192
    s_mov_b32 s22, 3200000
    s_mov_b32 s23, 0x20000
    s_mov_b32 s26, 3200000
    s_mov_b32 s27, 0x20000
    s_and_b32 s84, s2, 7
    s_lshl_b32 s84, s84, 5
    s_lshr_b32 s92, s2, 3
    s_add_u32 s84, s84, s92
    s_waitcnt lgkmcnt(0)
    s_mov_b64 s[20:21], s[12:13]
    s_mov_b64 s[24:25], s[10:11]
    buffer_load_dwordx4 v[84:87], v249, s[20:23], s60 offen
    s_mov_b64 exec, s[54:55]
    buffer_load_dwordx4 v[88:91], v249, s[20:23], s91 offen
    s_mov_b64 exec, -1
    ds_write_b128 v249, v[68:71]
    ds_write_b32 v3, v68 offset:8192
    ds_write_b128 v2, v[68:71]
    s_add_u32 s96, s32, 0x6c0000
    s_addc_u32 s97, s33, 0
    v_lshrrev_b32 v233, 5, v0
    v_and_b32 v1, 31, v0
    v_lshlrev_b32 v222, 2, v1
    s_lshl_b32 s91, s3, 11
    v_lshl_add_u32 v2, v233, 10, v222
    v_add_u32 v3, s91, v2
    s_waitcnt lgkmcnt(0)
    s_barrier
    s_load_dword s47, s[96:97], 0
    s_mov_b64 s[40:41], s[4:5]
    s_mov_b32 s42, 0x186a00
    s_mov_b32 s43, 0x20000
    s_mov_b64 s[36:37], s[6:7]
    s_mov_b32 s38, 0x124f8
    s_mov_b32 s39, 0x20000
    s_lshl_b32 s95, s3, 8
    s_add_u32 s95, s95, s84
    v_lshl_add_u32 v225, v1, 11, s95
    v_lshlrev_b32 v226, 4, v233
    v_lshl_add_u32 v225, v225, 7, v226
    s_lshr_b32 s91, s2, 3
    v_lshl_add_u32 v240, v0, 5, s91
    s_cmp_eq_u32 s3, 6
    s_cselect_b64 s[100:101], s[14:15], s[6:7]
    s_movk_i32 s92, 585
    s_cselect_b32 s92, 144, s92
    s_cmp_eq_u32 s3, 7
    s_cselect_b64 s[100:101], s[18:19], s[100:101]
    s_cselect_b32 s92, 127, s92
    s_cmp_ge_u32 s3, 5
    s_cselect_b32 s92, s92, -1
    v_cmp_ge_i32 vcc, s92, v240
    v_lshlrev_b32 v240, 7, v240
    s_mov_b64 exec, vcc
    global_load_dword v240, v240, s[100:101]
    s_mov_b64 exec, -1
    v_mov_b32 v217, v3
    s_and_b32 s91, s3, 3
    s_lshl_b32 s92, s91, 8
    s_add_u32 s92, s92, 16512
    v_add_u32 v216, s92, v2
    s_lshr_b32 s92, s3, 2
    s_mul_i32 s63, s92, 0x02020000
    s_add_u32 s63, s63, 0x01000c0c
    s_lshl_b32 s92, s92, 10
    s_lshl2_add_u32 s92, s91, s92
    s_add_u32 s92, s92, 146048
    v_add_u32 v210, s92, v248
    s_mov_b32 s34, 3200000
    s_mov_b32 s35, 0x20000
    s_mul_i32 s11, s3, 9
    s_min_u32 s91, s3, 2
    s_add_u32 s11, s11, s91
    s_lshl_b32 s11, s11, 10
    v_lshl_add_u32 v246, v233, 13, s95
    v_lshl_add_u32 v246, v246, 7, v222
    v_lshlrev_b32 v233, 4, v233
    v_mov_b32 v230, 1
    v_mov_b32 v247, v246
    v_mov_b32 v242, v222
    s_mov_b32 s61, 0x05040100
    s_mov_b32 s62, 0x07060302
    s_mov_b32 s94, 0xbfb8aa3b
    v_mov_b32 v206, 0
    v_mov_b32 v207, 0
    v_and_b32 v205, 15, v0
    v_lshrrev_b32 v204, 4, v0
    v_lshl_add_u32 v204, v204, 3, s3
    s_lshl_b32 s91, s84, 5
    v_cmp_gt_u32 vcc, 4, v205
    v_add_u32 v250, 4, v205
    v_cmp_lt_u32 s[100:101], 11, v205
    v_cndmask_b32 v250, v250, v205, vcc
    v_subrev_u32 v227, 8, v205
    v_cndmask_b32 v250, v250, v227, s[100:101]
    v_lshl_add_u32 v227, v250, 1, s91
    v_lshlrev_b32 v250, 2, v250
    v_lshl_add_u32 v227, v204, 13, v227
    v_mul_u32_u24 v243, 102400, v204
    v_mul_u32_u24 v204, 12800, v204
    s_and_b32 s91, s2, 0xf8
    s_add_u32 s91, s91, s3
    s_mul_i32 s91, s91, 49
    v_add_lshl_u32 v238, s91, v0, 7
    v_mul_u32_u24 v223, 2320, v205
    v_and_b32 v244, 48, v0
    v_lshlrev_b32 v244, 2, v244
    v_subrev_u32 v245, 160, v244
    v_and_b32 v214, 7, v0
    v_lshrrev_b32 v215, 3, v0
    v_lshlrev_b32 v212, 2, v214
    v_lshlrev_b32 v213, 2, v215
    s_add_u32 s99, s84, 12288
    s_mov_b32 s89, 0
    s_mov_b32 s10, 1
    s_mov_b32 s88, 0xffffffe0
    s_mov_b32 s98, 0
    s_sub_u32 s91, 11, s3
    s_cmp_lt_u32 s3, 4
    s_cselect_b32 s12, s3, s91
    s_lshl_b32 s87, s3, 7
    s_add_u32 s87, s87, 162432
    v_lshrrev_b32 v224, 3, v249
    v_and_b32 v224, -4, v224
    s_mov_b32 s64, 0xffff6000
    v_mov_b32 v72, 0
    v_add_u32 v208, 113280, v248
    v_lshl_add_u32 v226, s3, 11, v208
    s_add_u32 s28, s32, 0x320000
    s_addc_u32 s29, s33, 0
    s_mov_b32 s30, 0x200000
    s_mov_b32 s31, 0x20000
    s_add_u32 s48, s32, 0x520000
    s_addc_u32 s49, s33, 0
    s_mov_b32 s50, 0x188000
    s_mov_b32 s51, 0x20000
    s_add_u32 s85, s60, 8192
    buffer_load_dwordx4 v[92:95], v249, s[24:27], s60 offen
    s_mov_b64 exec, s[54:55]
    buffer_load_dwordx4 v[96:99], v249, s[24:27], s85 offen
    s_mov_b64 exec, -1
    s_waitcnt vmcnt(4)
    s_mov_b64 exec, s[52:53]
    v_cmp_le_u32 vcc, 12288, v84
    v_bfe_u32 v2, v84, 8, 3
    v_lshlrev_b32_sdwa v100, 5, v84 dst_sel:DWORD dst_unused:UNUSED_PAD src0_sel:DWORD src1_sel:BYTE_0
    v_lshl_add_u32 v3, v84, 2, s64
    v_lshl_or_b32 v100, v2, 2, v100
    v_cndmask_b32 v100, v100, v3, vcc
    ds_add_rtn_u32 v108, v100, v230
    v_cmp_le_u32 vcc, 12288, v85
    v_bfe_u32 v2, v85, 8, 3
    v_lshlrev_b32_sdwa v101, 5, v85 dst_sel:DWORD dst_unused:UNUSED_PAD src0_sel:DWORD src1_sel:BYTE_0
    v_lshl_add_u32 v3, v85, 2, s64
    v_lshl_or_b32 v101, v2, 2, v101
    v_cndmask_b32 v101, v101, v3, vcc
    ds_add_rtn_u32 v109, v101, v230
    v_cmp_le_u32 vcc, 12288, v86
    v_bfe_u32 v2, v86, 8, 3
    v_lshlrev_b32_sdwa v102, 5, v86 dst_sel:DWORD dst_unused:UNUSED_PAD src0_sel:DWORD src1_sel:BYTE_0
    v_lshl_add_u32 v3, v86, 2, s64
    v_lshl_or_b32 v102, v2, 2, v102
    v_cndmask_b32 v102, v102, v3, vcc
    ds_add_rtn_u32 v110, v102, v230
    v_cmp_le_u32 vcc, 12288, v87
    v_bfe_u32 v2, v87, 8, 3
    v_lshlrev_b32_sdwa v103, 5, v87 dst_sel:DWORD dst_unused:UNUSED_PAD src0_sel:DWORD src1_sel:BYTE_0
    v_lshl_add_u32 v3, v87, 2, s64
    v_lshl_or_b32 v103, v2, 2, v103
    v_cndmask_b32 v103, v103, v3, vcc
    ds_add_rtn_u32 v111, v103, v230
    s_mov_b64 exec, s[54:55]
    s_waitcnt vmcnt(3)
    s_cbranch_execz K_A1
    v_cmp_le_u32 vcc, 12288, v88
    v_bfe_u32 v2, v88, 8, 3
    v_lshlrev_b32_sdwa v104, 5, v88 dst_sel:DWORD dst_unused:UNUSED_PAD src0_sel:DWORD src1_sel:BYTE_0
    v_lshl_add_u32 v3, v88, 2, s64
    v_lshl_or_b32 v104, v2, 2, v104
    v_cndmask_b32 v104, v104, v3, vcc
    ds_add_rtn_u32 v112, v104, v230
    v_cmp_le_u32 vcc, 12288, v89
    v_bfe_u32 v2, v89, 8, 3
    v_lshlrev_b32_sdwa v105, 5, v89 dst_sel:DWORD dst_unused:UNUSED_PAD src0_sel:DWORD src1_sel:BYTE_0
    v_lshl_add_u32 v3, v89, 2, s64
    v_lshl_or_b32 v105, v2, 2, v105
    v_cndmask_b32 v105, v105, v3, vcc
    ds_add_rtn_u32 v113, v105, v230
    v_cmp_le_u32 vcc, 12288, v90
    v_bfe_u32 v2, v90, 8, 3
    v_lshlrev_b32_sdwa v106, 5, v90 dst_sel:DWORD dst_unused:UNUSED_PAD src0_sel:DWORD src1_sel:BYTE_0
    v_lshl_add_u32 v3, v90, 2, s64
    v_lshl_or_b32 v106, v2, 2, v106
    v_cndmask_b32 v106, v106, v3, vcc
    ds_add_rtn_u32 v114, v106, v230
    v_cmp_le_u32 vcc, 12288, v91
    v_bfe_u32 v2, v91, 8, 3
    v_lshlrev_b32_sdwa v107, 5, v91 dst_sel:DWORD dst_unused:UNUSED_PAD src0_sel:DWORD src1_sel:BYTE_0
    v_lshl_add_u32 v3, v91, 2, s64
    v_lshl_or_b32 v107, v2, 2, v107
    v_cndmask_b32 v107, v107, v3, vcc
    ds_add_rtn_u32 v115, v107, v230
K_A1:
    s_mov_b64 exec, -1
    s_mov_b32 exec_lo, 0x7f
    s_mov_b32 exec_hi, 0x7f
    buffer_load_dwordx4 v[144:147], v225, s[40:43], 0 offen offset:0
    buffer_load_dwordx4 v[148:151], v225, s[40:43], 0 offen offset:32
    buffer_load_dwordx4 v[140:143], v225, s[40:43], 0 offen offset:64
    buffer_load_dwordx4 v[124:127], v225, s[40:43], 0 offen offset:96
    s_mov_b64 exec, -1
    s_waitcnt lgkmcnt(0)
    s_barrier
    ds_read_b128 v[68:71], v249
    s_mov_b32 exec_lo, 0xaaaaaaaa
    s_mov_b32 exec_hi, 0xaaaaaaaa
    ds_read_b32 v72, v224 offset:8192
    s_mov_b64 exec, -1
    s_add_u32 s91, s3, 1
    s_lshl_b32 s91, 0xff, s91
    s_and_b32 s91, s91, 0xff
    v_lshlrev_b32 v3, 2, v0
    s_lshl_b32 s92, s3, 2
    v_mov_b32 v221, s92
    s_waitcnt lgkmcnt(1)
    v_add_u32 v69, v68, v69
    v_add3_u32 v71, v69, v70, v71
    s_waitcnt lgkmcnt(0)
    v_add_u32 v75, v71, v72
    v_add_u32 v70, v69, v70
    s_nop 0
    v_add_u32_dpp v2, v75, v75 row_shr:1 row_mask:0xf bank_mask:0xf bound_ctrl:0
    s_nop 1
    v_add_u32_dpp v2, v2, v2 row_shr:2 row_mask:0xf bank_mask:0xf bound_ctrl:0
    s_nop 1
    v_add_u32_dpp v2, v2, v2 row_shr:4 row_mask:0xf bank_mask:0xf bound_ctrl:0
    s_nop 1
    v_add_u32_dpp v2, v2, v2 row_shr:8 row_mask:0xf bank_mask:0xf bound_ctrl:0
    s_nop 1
    v_add_u32_dpp v2, v2, v2 row_bcast:15 row_mask:0xa bank_mask:0xf
    s_nop 1
    v_add_u32_dpp v2, v2, v2 row_bcast:31 row_mask:0xc bank_mask:0xf
    s_nop 0
    v_readlane_b32 s85, v2, 63
    v_sub_u32 v2, v2, v75
    s_mov_b32 exec_hi, 0
    v_mov_b32 v228, s85
    s_mov_b32 exec_lo, s91
    ds_add_u32 v3, v228 offset:9216
    s_mov_b64 exec, -1
    s_waitcnt lgkmcnt(0)
    s_barrier
    ds_read_b32 v3, v221 offset:9216
    global_load_dword v4, v217, s[14:15] offset:0
    global_load_dword v5, v217, s[14:15] offset:128
    global_load_dword v6, v217, s[14:15] offset:256
    global_load_dword v7, v217, s[14:15] offset:384
    global_load_dword v8, v217, s[14:15] offset:512
    global_load_dword v9, v217, s[14:15] offset:640
    global_load_dword v10, v217, s[14:15] offset:768
    global_load_dword v11, v217, s[14:15] offset:896
    s_waitcnt lgkmcnt(0)
    v_add_u32 v76, v2, v3
    v_add_u32 v77, v76, v68
    v_add_u32 v78, v76, v69
    v_add_u32 v79, v76, v70
    v_add_u32 v80, v76, v71
    ds_write_b128 v249, v[76:79]
    s_mov_b32 exec_lo, 0xaaaaaaaa
    s_mov_b32 exec_hi, 0xaaaaaaaa
    ds_write_b32 v224, v80 offset:8192
    s_mov_b64 exec, -1
    v_lshlrev_b32 v3, 18, v249
    s_mov_b32 s65, 0x100000
    s_mov_b32 s66, 0x200000
    s_mov_b32 s67, 0x300000
    s_waitcnt lgkmcnt(0)
    s_barrier
    s_mov_b64 exec, s[52:53]
    ds_read_b32 v100, v100
    ds_read_b32 v101, v101
    ds_read_b32 v102, v102
    ds_read_b32 v103, v103
    s_mov_b64 exec, s[54:55]
    s_cbranch_execz K_A2
    ds_read_b32 v104, v104
    ds_read_b32 v105, v105
    ds_read_b32 v106, v106
    ds_read_b32 v107, v107
K_A2:
    s_mov_b64 exec, -1
    s_waitcnt vmcnt(12)
    global_load_dword v12, v217, s[18:19] offset:0
    global_load_dword v13, v217, s[18:19] offset:128
    global_load_dword v14, v217, s[18:19] offset:256
    global_load_dword v15, v217, s[18:19] offset:384
    global_load_dword v16, v217, s[18:19] offset:512
    global_load_dword v17, v217, s[18:19] offset:640
    global_load_dword v18, v217, s[18:19] offset:768
    global_load_dword v19, v217, s[18:19] offset:896
    global_load_dword v202, v216, s[14:15] offset:0
    global_load_dword v203, v216, s[14:15] offset:128
    s_mov_b64 exec, s[52:53]
    v_lshrrev_b32 v84, 8, v84
    v_lshl_or_b32 v84, v84, 14, v92
    v_or_b32 v84, v3, v84
    v_lshrrev_b32 v85, 8, v85
    v_lshl_or_b32 v85, v85, 14, v93
    v_or3_b32 v85, v85, v3, s65
    v_lshrrev_b32 v86, 8, v86
    v_lshl_or_b32 v86, v86, 14, v94
    v_or3_b32 v86, v86, v3, s66
    v_lshrrev_b32 v87, 8, v87
    v_lshl_or_b32 v87, v87, 14, v95
    v_or3_b32 v87, v87, v3, s67
    s_waitcnt lgkmcnt(0)
    v_add_lshl_u32 v100, v100, v108, 2
    ds_write_b32 v100, v84 offset:10240
    v_add_lshl_u32 v101, v101, v109, 2
    ds_write_b32 v101, v85 offset:10240
    v_add_lshl_u32 v102, v102, v110, 2
    ds_write_b32 v102, v86 offset:10240
    v_add_lshl_u32 v103, v103, v111, 2
    ds_write_b32 v103, v87 offset:10240
    s_mov_b64 exec, s[54:55]
    s_cbranch_execz K_A3
    v_or_b32 v3, 0x80000000, v3
    v_lshrrev_b32 v88, 8, v88
    v_lshl_or_b32 v88, v88, 14, v96
    v_or_b32 v88, v3, v88
    v_add_lshl_u32 v104, v104, v112, 2
    ds_write_b32 v104, v88 offset:10240
    v_lshrrev_b32 v89, 8, v89
    v_lshl_or_b32 v89, v89, 14, v97
    v_or3_b32 v89, v89, v3, s65
    v_add_lshl_u32 v105, v105, v113, 2
    ds_write_b32 v105, v89 offset:10240
    v_lshrrev_b32 v90, 8, v90
    v_lshl_or_b32 v90, v90, 14, v98
    v_or3_b32 v90, v90, v3, s66
    v_add_lshl_u32 v106, v106, v114, 2
    ds_write_b32 v106, v90 offset:10240
    v_lshrrev_b32 v91, 8, v91
    v_lshl_or_b32 v91, v91, 14, v99
    v_or3_b32 v91, v91, v3, s67
    v_add_lshl_u32 v107, v107, v115, 2
    ds_write_b32 v107, v91 offset:10240
K_A3:
    s_mov_b64 exec, -1
    s_waitcnt vmcnt(10)
    v_perm_b32 v52, v5, v4, s61
    v_perm_b32 v56, v5, v4, s62
    v_perm_b32 v53, v7, v6, s61
    v_perm_b32 v57, v7, v6, s62
    v_perm_b32 v54, v9, v8, s61
    v_perm_b32 v58, v9, v8, s62
    v_perm_b32 v55, v11, v10, s61
    v_perm_b32 v59, v11, v10, s62
    ds_write_b128 v226, v[52:55] offset:0
    ds_write_b128 v226, v[56:59] offset:1024
    s_add_u32 s91, s60, 8192
    s_waitcnt lgkmcnt(0)
    s_barrier
    ds_read_b128 v[20:23], v249 offset:10240
    ds_read_b128 v[24:27], v249 offset:18432
    s_add_u32 s47, s47, 1
    s_and_b32 s92, s47, 15
    s_mul_i32 s92, s92, 0x10100
    s_xor_b32 s92, s92, 0x20100
    s_and_b32 s46, s47, 0xfff0f0ff
    s_or_b32 s46, s46, s92
    s_waitcnt lgkmcnt(1)
    buffer_store_dwordx4 v[20:23], v249, s[32:35], s60 offen sc1
    s_mov_b64 exec, s[54:55]
    s_waitcnt lgkmcnt(0)
    buffer_store_dwordx4 v[24:27], v249, s[32:35], s91 offen sc1
    s_mov_b64 exec, -1
    ds_read_b128 v[84:87], v208 offset:8192
    ds_read_b128 v[88:91], v208 offset:10240
    ds_read_b128 v[92:95], v208 offset:12288
    ds_read_b128 v[96:99], v208 offset:14336
    ds_read_b128 v[100:103], v208 offset:9216
    ds_read_b128 v[104:107], v208 offset:11264
    ds_read_b128 v[108:111], v208 offset:13312
    ds_read_b128 v[112:115], v208 offset:15360
    s_bfe_u32 s56, s46, 0x40000
    s_bfe_u32 s92, s46, 0x40004
    s_pack_ll_b32_b16 s56, s56, s92
    s_lshl_b32 s56, s56, 12
    s_bfe_u32 s57, s46, 0x40008
    s_bfe_u32 s92, s46, 0x4000c
    s_pack_ll_b32_b16 s57, s57, s92
    s_lshl_b32 s57, s57, 12
    s_bfe_u32 s58, s46, 0x40010
    s_bfe_u32 s92, s46, 0x40014
    s_pack_ll_b32_b16 s58, s58, s92
    s_lshl_b32 s58, s58, 12
    s_bfe_u32 s59, s46, 0x40018
    s_bfe_u32 s92, s46, 0x4001c
    s_pack_ll_b32_b16 s59, s59, s92
    s_lshl_b32 s59, s59, 12
    s_waitcnt vmcnt(2) lgkmcnt(0)
    v_mfma_f32_32x32x16_bf16 v[36:51], v[144:147], v[84:87], 0
    v_perm_b32 v28, v13, v12, s61
    v_perm_b32 v32, v13, v12, s62
    v_perm_b32 v29, v15, v14, s61
    v_perm_b32 v33, v15, v14, s62
    v_mfma_f32_32x32x16_bf16 v[36:51], v[148:151], v[88:91], v[36:51]
    v_perm_b32 v30, v17, v16, s61
    v_perm_b32 v34, v17, v16, s62
    v_perm_b32 v31, v19, v18, s61
    v_mfma_f32_32x32x16_bf16 v[36:51], v[140:143], v[92:95], v[36:51]
    v_perm_b32 v35, v19, v18, s62
    ds_write_b128 v226, v[28:31] offset:16384
    ds_write_b128 v226, v[32:35] offset:17408
    v_perm_b32 v202, v202, v202, s63
    v_mfma_f32_32x32x16_bf16 v[36:51], v[124:127], v[96:99], v[36:51]
    v_perm_b32 v203, v203, v203, s63
    v_mul_f32 v202, s94, v202
    v_mul_f32 v203, s94, v203
    v_mfma_f32_32x32x16_bf16 v[52:67], v[144:147], v[100:103], 0
    v_cvt_pk_bf16_f32 v202, v202, v203
    ds_write_b32 v210, v202
    v_add_u32 v81, v76, v75
    v_lshl_or_b32 v160, v77, 16, v76
    v_mfma_f32_32x32x16_bf16 v[52:67], v[148:151], v[104:107], v[52:67]
    v_lshl_or_b32 v161, v79, 16, v78
    v_sub_u32_dpp v2, v76, v81 quad_perm:[0,0,2,2] row_mask:0xf bank_mask:0xf
    v_mov_b32 v3, 800
    v_mfma_f32_32x32x16_bf16 v[52:67], v[140:143], v[108:111], v[52:67]
    v_cmp_gt_i32 vcc, 0xffffffe0, v2
    v_lshl_or_b32 v162, v81, 16, v80
    v_or_b32 v160, s56, v160
    v_cndmask_b32 v3, 0, v3, vcc
    v_mfma_f32_32x32x16_bf16 v[52:67], v[124:127], v[112:115], v[52:67]
    v_or_b32 v161, s57, v161
    v_or_b32 v162, s58, v162
    v_add3_u32 v163, v81, v3, s59
    s_lshl_b32 s60, s2, 13
    s_mov_b32 s64, 0x7fffffff
    s_mov_b32 s65, 0x80000000
    s_mov_b32 s66, 0x7fff0000
    s_add_u32 m0, s11, 37504
    s_add_u32 s13, s11, 0
    buffer_load_dwordx4 v248, s[36:39], s13 offen offset:0 lds
    buffer_load_dwordx4 v248, s[36:39], s13 offen offset:1024 lds
    buffer_load_dwordx4 v248, s[36:39], s13 offen offset:2048 lds
    s_waitcnt vmcnt(3) lgkmcnt(0)
    s_barrier
    buffer_store_dwordx4 v[160:163], v249, s[28:31], s60 offen sc1
    v_mul_f32 v36, s94, v36
    v_mul_f32 v52, s94, v52
    v_cvt_pk_bf16_f32 v36, v36, 0
    v_and_b32 v2, s64, v52
    v_add_u32 v2, 0x8000, v2
    v_and_or_b32 v52, v52, s65, v36
    v_sub_u32 v2, v2, v36 clamp
    s_mov_b32 s91, 0
    v_bfi_b32 v72, s66, v2, v52
    buffer_store_dword v72, v246, s[48:51], s91 offen sc1
    v_mul_f32 v37, s94, v37
    v_mul_f32 v53, s94, v53
    v_cvt_pk_bf16_f32 v37, v37, 0
    v_and_b32 v2, s64, v53
    v_add_u32 v2, 0x8000, v2
    v_and_or_b32 v53, v53, s65, v37
    v_sub_u32 v2, v2, v37 clamp
    s_mov_b32 s91, 262144
    v_bfi_b32 v73, s66, v2, v53
    buffer_store_dword v73, v246, s[48:51], s91 offen sc1
    v_mul_f32 v38, s94, v38
    v_mul_f32 v54, s94, v54
    v_cvt_pk_bf16_f32 v38, v38, 0
    v_and_b32 v2, s64, v54
    v_add_u32 v2, 0x8000, v2
    v_and_or_b32 v54, v54, s65, v38
    v_sub_u32 v2, v2, v38 clamp
    s_mov_b32 s91, 524288
    v_bfi_b32 v74, s66, v2, v54
    buffer_store_dword v74, v246, s[48:51], s91 offen sc1
    v_mul_f32 v39, s94, v39
    v_mul_f32 v55, s94, v55
    v_cvt_pk_bf16_f32 v39, v39, 0
    v_and_b32 v2, s64, v55
    v_add_u32 v2, 0x8000, v2
    v_and_or_b32 v55, v55, s65, v39
    v_sub_u32 v2, v2, v39 clamp
    s_mov_b32 s91, 786432
    v_bfi_b32 v75, s66, v2, v55
    buffer_store_dword v75, v246, s[48:51], s91 offen sc1
    s_add_u32 s14, s14, 16384
    s_addc_u32 s15, s15, 0
    global_load_dword v241, v222, s[14:15]
    buffer_load_dwordx4 v248, s[36:39], s13 offen offset:3072 lds
    ds_read_b128 v[4:7], v208 offset:0
    ds_read_b128 v[8:11], v208 offset:2048
    ds_read_b128 v[12:15], v208 offset:4096
    ds_read_b128 v[16:19], v208 offset:6144
    s_add_u32 m0, s11, 41600
    s_add_u32 s13, s11, 4096
    buffer_load_dwordx4 v248, s[36:39], s13 offen offset:0 lds
    ds_read_b128 v[20:23], v208 offset:1024
    ds_read_b128 v[24:27], v208 offset:3072
    ds_read_b128 v[28:31], v208 offset:5120
    ds_read_b128 v[32:35], v208 offset:7168
    buffer_load_dwordx4 v248, s[36:39], s13 offen offset:1024 lds
    ds_read_b128 v[168:171], v208 offset:24576
    ds_read_b128 v[172:175], v208 offset:26624
    ds_read_b128 v[176:179], v208 offset:28672
    ds_read_b128 v[180:183], v208 offset:30720
    buffer_load_dwordx4 v248, s[36:39], s13 offen offset:2048 lds
    ds_read_b128 v[184:187], v208 offset:25600
    ds_read_b128 v[188:191], v208 offset:27648
    ds_read_b128 v[192:195], v208 offset:29696
    buffer_load_dwordx4 v248, s[36:39], s13 offen offset:3072 lds
    ds_read_b128 v[196:199], v208 offset:31744
    ds_read_b128 v[36:39], v208 offset:16384
    ds_read_b128 v[40:43], v208 offset:18432
    ds_read_b128 v[44:47], v208 offset:20480
    s_add_u32 m0, s11, 45696
    s_add_u32 s13, s11, 8192
    buffer_load_dwordx4 v248, s[36:39], s13 offen offset:0 lds
    ds_read_b128 v[48:51], v208 offset:22528
    ds_read_b128 v[52:55], v208 offset:17408
    ds_read_b128 v[56:59], v208 offset:19456
    ds_read_b128 v[60:63], v208 offset:21504
    s_cmp_lt_u32 s3, 2
    s_cselect_b64 exec, -1, 0
    buffer_load_dwordx4 v248, s[36:39], s13 offen offset:1024 lds
    s_mov_b64 exec, -1
    ds_read_b128 v[64:67], v208 offset:23552
    ds_read_b128 v[116:119], v208 offset:32768
    ds_read_b128 v[120:123], v208 offset:33792
    s_mov_b32 s96, 0
    s_mov_b32 s97, -1
    v_bfe_u32 v250, s46, v250, 4
    v_lshlrev_b32 v250, 12, v250
    v_mul_u32_u24 v228, 48, v205
    v_add_u32 v228, 162432, v228
    v_mov_b32 v230, 0x3f803f80
    v_mov_b32 v218, 0
    v_mov_b32 v219, 0
    v_mov_b32 v220, 0
    s_lshl_b32 s91, s3, 12
    s_add_u32 s91, s91, 113280
    v_add_u32 v226, s91, v248
    v_lshl_add_u32 v237, v0, 6, s91
    v_bfe_u32 v224, v0, 2, 2
    v_lshrrev_b32 v221, 2, v233
    v_add_u32 v224, v224, v221
    v_lshl_add_u32 v235, v224, 6, s91
    v_bfe_u32 v224, v0, 4, 1
    v_and_b32 v221, 3, v0
    v_lshl_add_u32 v224, v224, 2, v221
    v_lshl_add_u32 v235, v224, 3, v235
    s_lshl_b32 s91, s3, 11
    s_add_u32 s91, s91, 146048
    v_add_u32 v225, s91, v248
    v_lshl_add_u32 v236, v0, 5, s91
    v_lshl_add_u32 v234, v1, 5, s91
    v_add_u32 v234, v234, v233
    v_lshlrev_b32 v224, 2, v0
    v_mov_b32 v221, 50000
    ds_write_b32 v224, v221 offset:18560
    v_add_u32 v249, 0x6b0000, v248
    v_mov_b32 v68, 0
    v_mov_b32 v69, 0
    v_mov_b32 v70, 0
    v_mov_b32 v71, 0
    v_mov_b32 v2, v204
    v_mov_b32 v3, v205
    s_waitcnt vmcnt(8) lgkmcnt(0)
    s_barrier
    s_lshl2_add_u32 s91, s2, 0x6b0000
    v_mov_b32 v210, s91
    v_mov_b32 v211, s46
    s_cmp_eq_u32 s3, 0
    s_cselect_b64 exec, 1, 0
    global_store_dword v210, v211, s[32:33] sc1
    s_mov_b64 exec, -1
    buffer_load_ushort v100, v227, s[28:31], 0 offen sc1
    s_mov_b32 s91, 262144
    buffer_load_ushort v101, v227, s[28:31], s91 offen sc1
    s_mov_b32 s91, 524288
    buffer_load_ushort v102, v227, s[28:31], s91 offen sc1
    s_mov_b32 s91, 786432
    buffer_load_ushort v103, v227, s[28:31], s91 offen sc1
    s_mov_b32 s91, 1048576
    buffer_load_ushort v104, v227, s[28:31], s91 offen sc1
    s_mov_b32 s91, 1310720
    buffer_load_ushort v105, v227, s[28:31], s91 offen sc1
    s_mov_b32 s91, 1572864
    buffer_load_ushort v106, v227, s[28:31], s91 offen sc1
    s_mov_b32 s91, 1835008
    buffer_load_ushort v107, v227, s[28:31], s91 offen sc1
    s_mov_b32 exec_lo, 0xfffff
    s_mov_b32 exec_hi, 0x0
    buffer_load_dword v239, v238, s[48:51], 0 offen sc1
    s_mov_b64 exec, -1
    ds_write_b128 v226, v[68:71] offset:0
    ds_write_b128 v226, v[68:71] offset:1024
    ds_write_b128 v226, v[68:71] offset:2048
    ds_write_b128 v226, v[68:71] offset:3072
    ds_write_b128 v225, v[68:71] offset:0
    ds_write_b128 v225, v[68:71] offset:1024
    s_mov_b32 s21, 409600
    s_mov_b32 s22, 819200
    s_mov_b32 s23, 1228800
    s_mov_b32 s24, 1638400
    s_mov_b32 s25, 2048000
    s_mov_b32 s26, 2457600
    s_mov_b32 s27, 2867200
    s_mov_b32 s86, 0
    s_waitcnt vmcnt(1)
K_POLL:
    v_xor_b32 v100, v100, v250
    v_xor_b32 v101, v101, v250
    v_xor_b32 v102, v102, v250
    v_xor_b32 v103, v103, v250
    v_xor_b32 v104, v104, v250
    v_xor_b32 v105, v105, v250
    v_xor_b32 v106, v106, v250
    v_xor_b32 v107, v107, v250
    v_or3_b32 v224, v100, v101, v102
    v_or3_b32 v221, v103, v104, v105
    v_or3_b32 v224, v224, v106, v107
    v_or_b32 v224, v224, v221
    v_cmp_lt_u32 vcc, 0xfff, v224
    s_cbranch_vccnz K_RETRY
K_GOT:
    v_add_u32_dpp v160, v100, v3 row_newbcast:0 row_mask:0xf bank_mask:0xf
    v_lshl_add_u32 v132, v160, 2, v2
    buffer_load_dword v84, v132, s[32:35], 0 offen sc1
    v_add_u32_dpp v161, v101, v3 row_newbcast:0 row_mask:0xf bank_mask:0xf
    v_lshl_add_u32 v133, v161, 2, v2
    buffer_load_dword v85, v133, s[32:35], s21 offen sc1
    v_add_u32_dpp v162, v102, v3 row_newbcast:0 row_mask:0xf bank_mask:0xf
    v_lshl_add_u32 v134, v162, 2, v2
    buffer_load_dword v86, v134, s[32:35], s22 offen sc1
    v_add_u32_dpp v163, v103, v3 row_newbcast:0 row_mask:0xf bank_mask:0xf
    v_lshl_add_u32 v200, v163, 2, v2
    buffer_load_dword v87, v200, s[32:35], s23 offen sc1
    v_add_u32_dpp v164, v104, v3 row_newbcast:0 row_mask:0xf bank_mask:0xf
    v_lshl_add_u32 v136, v164, 2, v2
    buffer_load_dword v88, v136, s[32:35], s24 offen sc1
    v_add_u32_dpp v165, v105, v3 row_newbcast:0 row_mask:0xf bank_mask:0xf
    v_lshl_add_u32 v137, v165, 2, v2
    buffer_load_dword v89, v137, s[32:35], s25 offen sc1
    v_add_u32_dpp v166, v106, v3 row_newbcast:0 row_mask:0xf bank_mask:0xf
    v_lshl_add_u32 v138, v166, 2, v2
    buffer_load_dword v90, v138, s[32:35], s26 offen sc1
    v_add_u32_dpp v167, v107, v3 row_newbcast:0 row_mask:0xf bank_mask:0xf
    v_lshl_add_u32 v139, v167, 2, v2
    buffer_load_dword v91, v139, s[32:35], s27 offen sc1
    v_sub_u32_dpp v68, v100, v100 row_shl:1 row_mask:0xf bank_mask:0xf bound_ctrl:0
    v_sub_u32_dpp v69, v101, v101 row_shl:1 row_mask:0xf bank_mask:0xf bound_ctrl:0
    v_sub_u32_dpp v70, v102, v102 row_shl:1 row_mask:0xf bank_mask:0xf bound_ctrl:0
    v_sub_u32_dpp v71, v103, v103 row_shl:1 row_mask:0xf bank_mask:0xf bound_ctrl:0
    v_sub_u32_dpp v72, v104, v104 row_shl:1 row_mask:0xf bank_mask:0xf bound_ctrl:0
    v_sub_u32_dpp v73, v105, v105 row_shl:1 row_mask:0xf bank_mask:0xf bound_ctrl:0
    v_sub_u32_dpp v74, v106, v106 row_shl:1 row_mask:0xf bank_mask:0xf bound_ctrl:0
    v_sub_u32_dpp v75, v107, v107 row_shl:1 row_mask:0xf bank_mask:0xf bound_ctrl:0
    s_mov_b32 exec_lo, 0x03ff03ff
    s_mov_b32 exec_hi, 0x03ff03ff
    ds_add_rtn_u32 v108, v228, v68 offset:0
    ds_add_rtn_u32 v109, v228, v69 offset:4
    ds_add_rtn_u32 v110, v228, v70 offset:8
    ds_add_rtn_u32 v111, v228, v71 offset:12
    ds_add_rtn_u32 v112, v228, v72 offset:16
    ds_add_rtn_u32 v113, v228, v73 offset:20
    ds_add_rtn_u32 v114, v228, v74 offset:24
    ds_add_rtn_u32 v115, v228, v75 offset:28
    s_mov_b64 exec, -1
    v_sub_u32_dpp v160, v100, v160 row_newbcast:9 row_mask:0xf bank_mask:0xf
    v_sub_u32_dpp v161, v101, v161 row_newbcast:9 row_mask:0xf bank_mask:0xf
    v_sub_u32_dpp v162, v102, v162 row_newbcast:9 row_mask:0xf bank_mask:0xf
    v_sub_u32_dpp v163, v103, v163 row_newbcast:9 row_mask:0xf bank_mask:0xf
    v_sub_u32_dpp v164, v104, v164 row_newbcast:9 row_mask:0xf bank_mask:0xf
    v_sub_u32_dpp v165, v105, v165 row_newbcast:9 row_mask:0xf bank_mask:0xf
    v_sub_u32_dpp v166, v106, v166 row_newbcast:9 row_mask:0xf bank_mask:0xf
    v_sub_u32_dpp v167, v107, v167 row_newbcast:9 row_mask:0xf bank_mask:0xf
    v_cmp_lt_i32 s[54:55], 16, v160
    v_cmp_lt_i32 s[58:59], 16, v161
    v_cmp_lt_i32 s[62:63], 16, v162
    v_cmp_lt_i32 s[66:67], 16, v163
    v_cmp_lt_i32 s[70:71], 16, v164
    v_cmp_lt_i32 s[74:75], 16, v165
    v_cmp_lt_i32 s[78:79], 16, v166
    v_cmp_lt_i32 s[82:83], 16, v167
    s_mov_b64 exec, s[54:55]
    buffer_load_dword v92, v132, s[32:35], 0 offen offset:64 sc1
    s_mov_b64 exec, s[58:59]
    buffer_load_dword v93, v133, s[32:35], s21 offen offset:64 sc1
    s_mov_b64 exec, s[62:63]
    buffer_load_dword v94, v134, s[32:35], s22 offen offset:64 sc1
    s_mov_b64 exec, s[66:67]
    buffer_load_dword v95, v200, s[32:35], s23 offen offset:64 sc1
    s_mov_b64 exec, s[70:71]
    buffer_load_dword v96, v136, s[32:35], s24 offen offset:64 sc1
    s_mov_b64 exec, s[74:75]
    buffer_load_dword v97, v137, s[32:35], s25 offen offset:64 sc1
    s_mov_b64 exec, s[78:79]
    buffer_load_dword v98, v138, s[32:35], s26 offen offset:64 sc1
    s_mov_b64 exec, s[82:83]
    buffer_load_dword v99, v139, s[32:35], s27 offen offset:64 sc1
    s_mov_b64 exec, -1
    s_waitcnt lgkmcnt(0)
    s_barrier
    ds_read_b128 v[68:71], v228
    ds_read_b128 v[72:75], v228 offset:16
    s_mov_b32 exec_lo, 0xfff00000
    s_mov_b32 exec_hi, 0x3
    buffer_load_dword v239, v238, s[48:51], 0 offen sc1
    s_mov_b64 exec, -1
    v_sub_u32 v152, v108, v100
    v_sub_u32 v153, v109, v101
    v_sub_u32 v154, v110, v102
    v_sub_u32 v155, v111, v103
    v_sub_u32 v156, v112, v104
    v_sub_u32 v157, v113, v105
    v_sub_u32 v158, v114, v106
    v_sub_u32 v159, v115, v107
    s_waitcnt lgkmcnt(1)
    v_add_u32 v69, v69, v68
    v_add_u32 v70, v70, v69
    v_add_u32 v71, v71, v70
    s_waitcnt lgkmcnt(0)
    v_add_u32 v72, v72, v71
    v_add_u32 v73, v73, v72
    v_add_u32 v74, v74, v73
    v_add_u32 v240, v75, v74
    v_add_u32 v153, v153, v68
    v_lshl_add_u32 v216, v240, 3, v3
    v_readlane_b32 s92, v240, 8
    v_add_u32 v154, v154, v69
    v_min_u32_dpp v216, v216, v216 row_half_mirror row_mask:0xf bank_mask:0xf
    v_add_u32 v155, v155, v70
    v_add_u32 v156, v156, v71
    v_min_u32_dpp v216, v216, v216 quad_perm:[1,0,3,2] row_mask:0xf bank_mask:0xf
    v_add_u32 v157, v157, v72
    v_add_u32 v158, v158, v73
    v_min_u32_dpp v216, v216, v216 quad_perm:[2,3,0,1] row_mask:0xf bank_mask:0xf
    v_add_u32 v159, v159, v74
    v_readfirstlane_b32 s91, v216
    v_cmp_eq_u32 vcc, 8, v3
    s_and_b32 s90, s91, 7
    s_lshr_b32 s86, s91, 3
    s_add_u32 s92, s92, s86
    s_mul_i32 s85, s90, 580
    s_add_u32 s91, s86, s85
    s_lshl_b32 s91, s91, 2
    v_cndmask_b32 v240, v240, v206, vcc
    v_mov_b32 v225, s91
    v_mov_b32 v226, s92
    v_cndmask_b32 v223, v223, v225, vcc
    v_cmp_eq_u32 vcc, s90, v3
    v_sub_u32 v223, v223, v2
    s_nop 0
    v_cndmask_b32 v240, v240, v226, vcc
    v_cmp_lt_u32 vcc, 576, v240
    v_cmp_gt_u32 s[100:101], 64, v70
    s_nop 0
    s_and_b32 s100, s100, 0xff
    s_cbranch_scc1 K_SLOW0
    s_cbranch_vccnz K_SLOW0
    v_lshl_add_u32 v152, v152, 2, v223
    v_cmp_lt_i32 s[52:53], 0, v160
    s_waitcnt vmcnt(16)
    v_bfe_u32 v68, v84, 12, 8
    v_and_or_b32 v69, v68, 28, v244
    v_add_u32 v68, v68, v245
    v_max_i32 v68, v68, v69
    ds_bpermute_b32 v100, v68, v152
    ds_bpermute_b32 v210, v212, v240
    ds_bpermute_b32 v211, v213, v240
    s_mov_b32 exec_lo, 0x0
    s_mov_b32 exec_hi, 0x7c
    buffer_load_dword v239, v238, s[48:51], 0 offen sc1
    s_mov_b64 exec, -1
    v_lshl_add_u32 v153, v153, 2, v223
    v_cmp_lt_i32 s[56:57], 0, v161
    s_waitcnt vmcnt(16)
    v_bfe_u32 v70, v85, 12, 8
    v_and_or_b32 v71, v70, 28, v244
    v_add_u32 v70, v70, v245
    v_max_i32 v70, v70, v71
    ds_bpermute_b32 v101, v70, v153
    v_and_b32 v212, 56, v0
    v_lshl_add_u32 v154, v154, 2, v223
    v_cmp_lt_i32 s[60:61], 0, v162
    s_waitcnt vmcnt(15)
    v_bfe_u32 v72, v86, 12, 8
    v_and_or_b32 v73, v72, 28, v244
    v_add_u32 v72, v72, v245
    v_max_i32 v72, v72, v73
    ds_bpermute_b32 v102, v72, v154
    s_waitcnt lgkmcnt(3)
    v_lshl_add_u32 v210, v210, 3, v214
    s_waitcnt lgkmcnt(2)
    v_lshl_add_u32 v211, v211, 3, v215
    v_cmp_gt_u32 vcc, v210, v211
    s_mov_b32 exec_lo, 0x0
    s_mov_b32 exec_hi, 0xf80
    buffer_load_dword v239, v238, s[48:51], 0 offen sc1
    s_mov_b64 exec, -1
    s_waitcnt vmcnt(10)
    v_bfe_u32 v68, v92, 12, 8
    v_and_or_b32 v69, v68, 28, v244
    v_add_u32 v68, v68, v245
    v_max_i32 v68, v68, v69
    ds_bpermute_b32 v108, v68, v152
    v_lshrrev_b64 v[212:213], v212, vcc
    v_and_b32 v212, 0xff, v212
    v_bcnt_u32_b32 v212, v212, 0
    v_cmp_eq_u32 vcc, s12, v212
    s_mov_b32 s91, 0
    s_mov_b64 exec, s[52:53]
    v_lshrrev_b32 v77, 15, v84
    v_lshlrev_b16 v76, 2, v84
    v_add3_u32 v77, v77, v243, s91
    v_add_u32 v100, v100, v132
    ds_write2st64_b32 v100, v76, v77 offset0:0 offset1:74
    s_mov_b64 exec, -1
    s_waitcnt vmcnt(9)
    v_bfe_u32 v70, v93, 12, 8
    v_and_or_b32 v71, v70, 28, v244
    v_add_u32 v70, v70, v245
    v_max_i32 v70, v70, v71
    ds_bpermute_b32 v109, v70, v153
    s_ff1_i32_b64 s12, vcc
    s_lshr_b32 s12, s12, 3
    s_lshl_b32 s95, s12, 8
    s_add_u32 s95, s95, s84
    v_cmp_eq_u32 vcc, 6, v1
    s_mov_b32 exec_lo, 0x0
    s_mov_b32 exec_hi, 0x1f000
    buffer_load_dword v239, v238, s[48:51], 0 offen sc1
    s_mov_b64 exec, -1
    s_mov_b32 s91, 3276800
    s_mov_b64 exec, s[56:57]
    v_lshrrev_b32 v79, 15, v85
    v_lshlrev_b16 v78, 2, v85
    v_add3_u32 v79, v79, v243, s91
    s_waitcnt lgkmcnt(4)
    v_add_u32 v101, v101, v133
    ds_write2st64_b32 v101, v78, v79 offset0:0 offset1:74
    s_mov_b64 exec, -1
    s_waitcnt vmcnt(9)
    v_bfe_u32 v72, v94, 12, 8
    v_and_or_b32 v73, v72, 28, v244
    v_add_u32 v72, v72, v245
    v_max_i32 v72, v72, v73
    ds_bpermute_b32 v110, v72, v154
    v_mov_b32 v225, s99
    v_lshl_add_u32 v221, v1, 11, s95
    v_readlane_b32 s85, v240, s12
    v_cndmask_b32 v221, v221, v225, vcc
    v_lshl_add_u32 v225, v221, 7, v233
    s_mul_i32 s93, s12, 2320
    s_mov_b32 s91, 6553600
    s_mov_b64 exec, s[60:61]
    v_lshrrev_b32 v81, 15, v86
    v_lshlrev_b16 v80, 2, v86
    v_add3_u32 v81, v81, v243, s91
    s_waitcnt lgkmcnt(5)
    v_add_u32 v102, v102, v134
    ds_write2st64_b32 v102, v80, v81 offset0:0 offset1:74
    s_mov_b32 s91, 0
    s_mov_b64 exec, s[54:55]
    v_lshrrev_b32 v77, 15, v92
    v_lshlrev_b16 v76, 2, v92
    v_add3_u32 v77, v77, v243, s91
    s_waitcnt lgkmcnt(5)
    v_add3_u32 v108, v108, v132, 64
    ds_write2st64_b32 v108, v76, v77 offset0:0 offset1:74
    s_mov_b32 s91, 3276800
    s_mov_b64 exec, s[58:59]
    v_lshrrev_b32 v79, 15, v93
    v_lshlrev_b16 v78, 2, v93
    v_add3_u32 v79, v79, v243, s91
    s_waitcnt lgkmcnt(4)
    v_add3_u32 v109, v109, v133, 64
    ds_write2st64_b32 v109, v78, v79 offset0:0 offset1:74
    s_mov_b32 s91, 6553600
    s_mov_b64 exec, s[62:63]
    v_lshrrev_b32 v81, 15, v94
    v_lshlrev_b16 v80, 2, v94
    v_add3_u32 v81, v81, v243, s91
    s_waitcnt lgkmcnt(3)
    v_add3_u32 v110, v110, v134, 64
    ds_write2st64_b32 v110, v80, v81 offset0:0 offset1:74
    s_mov_b64 exec, -1
    s_mov_b64 s[20:21], s[8:9]
    s_mov_b32 s22, 0x186a000
    s_mov_b32 s23, 0x20000
    s_add_u32 s24, s32, 0x520000
    s_addc_u32 s25, s33, 0
    s_or_b32 s25, s25, 0x80000000
    s_mov_b32 s26, 0x186a00
    s_mov_b32 s27, 0xc00000
    v_lshl_add_u32 v232, v0, 2, s93
    v_add_u32 v231, s93, v233
    v_mov_b32 v2, 0x6c0000
    v_mov_b32 v3, s47
    s_or_b32 s91, s2, s3
    s_cselect_b64 exec, 0, 1
    global_store_dword v2, v3, s[32:33] sc1
    s_mov_b32 exec_lo, 0x7f
    s_mov_b32 exec_hi, 0x7f
    buffer_load_dwordx4 v[144:147], v225, s[40:43], 0 offen offset:0
    buffer_load_dwordx4 v[148:151], v225, s[40:43], 0 offen offset:32
    buffer_load_dwordx4 v[140:143], v225, s[40:43], 0 offen offset:64
    buffer_load_dwordx4 v[124:127], v225, s[40:43], 0 offen offset:96
    s_mov_b64 exec, -1
    s_mov_b32 s47, 0
    global_load_dwordx4 v[128:131], v249, s[32:33] sc1
    s_waitcnt lgkmcnt(0)
    s_barrier
    ds_read2st64_b32 v[202:203], v232 offset0:0 offset1:74
    s_waitcnt lgkmcnt(0)
    v_and_b32 v208, s88, v203
    v_or_b32 v209, 16, v208
    s_nop 1
    v_permlane32_swap_b32 v208, v209
    buffer_load_dwordx4 v[132:135], v208, s[20:23], 0 offen
    v_lshl_add_u32 v155, v155, 2, v223
    v_cmp_lt_i32 s[64:65], 0, v163
    v_bfe_u32 v74, v87, 12, 8
    v_and_or_b32 v75, v74, 28, v244
    v_add_u32 v74, v74, v245
    v_max_i32 v74, v74, v75
    ds_bpermute_b32 v103, v74, v155
    v_lshl_add_u32 v156, v156, 2, v223
    v_cmp_lt_i32 s[68:69], 0, v164
    v_bfe_u32 v68, v88, 12, 8
    v_and_or_b32 v69, v68, 28, v244
    v_add_u32 v68, v68, v245
    v_max_i32 v68, v68, v69
    ds_bpermute_b32 v104, v68, v156
    v_lshl_add_u32 v157, v157, 2, v223
    v_cmp_lt_i32 s[72:73], 0, v165
    v_bfe_u32 v70, v89, 12, 8
    v_and_or_b32 v71, v70, 28, v244
    v_add_u32 v70, v70, v245
    v_max_i32 v70, v70, v71
    ds_bpermute_b32 v105, v70, v157
    v_lshl_add_u32 v158, v158, 2, v223
    v_cmp_lt_i32 s[76:77], 0, v166
    v_bfe_u32 v72, v90, 12, 8
    v_and_or_b32 v73, v72, 28, v244
    v_add_u32 v72, v72, v245
    v_max_i32 v72, v72, v73
    ds_bpermute_b32 v106, v72, v158
    s_mov_b32 s91, 9830400
    s_mov_b64 exec, s[64:65]
    v_lshrrev_b32 v83, 15, v87
    v_lshlrev_b16 v82, 2, v87
    v_add3_u32 v83, v83, v243, s91
    s_waitcnt lgkmcnt(3)
    v_add_u32 v103, v103, v200
    ds_write2st64_b32 v103, v82, v83 offset0:0 offset1:74
    s_mov_b64 exec, -1
    v_lshl_add_u32 v159, v159, 2, v223
    v_cmp_lt_i32 s[80:81], 0, v167
    v_bfe_u32 v74, v91, 12, 8
    v_and_or_b32 v75, v74, 28, v244
    v_add_u32 v74, v74, v245
    v_max_i32 v74, v74, v75
    ds_bpermute_b32 v107, v74, v159
    s_mov_b32 s91, 13107200
    s_mov_b64 exec, s[68:69]
    v_lshrrev_b32 v77, 15, v88
    v_lshlrev_b16 v76, 2, v88
    v_add3_u32 v77, v77, v243, s91
    s_waitcnt lgkmcnt(4)
    v_add_u32 v104, v104, v136
    ds_write2st64_b32 v104, v76, v77 offset0:0 offset1:74
    s_mov_b64 exec, -1
    s_waitcnt vmcnt(15)
    v_bfe_u32 v74, v95, 12, 8
    v_and_or_b32 v75, v74, 28, v244
    v_add_u32 v74, v74, v245
    v_max_i32 v74, v74, v75
    ds_bpermute_b32 v111, v74, v155
    s_mov_b32 s91, 16384000
    s_mov_b64 exec, s[72:73]
    v_lshrrev_b32 v79, 15, v89
    v_lshlrev_b16 v78, 2, v89
    v_add3_u32 v79, v79, v243, s91
    s_waitcnt lgkmcnt(5)
    v_add_u32 v105, v105, v137
    ds_write2st64_b32 v105, v78, v79 offset0:0 offset1:74
    s_mov_b64 exec, -1
    s_waitcnt vmcnt(14)
    v_bfe_u32 v68, v96, 12, 8
    v_and_or_b32 v69, v68, 28, v244
    v_add_u32 v68, v68, v245
    v_max_i32 v68, v68, v69
    ds_bpermute_b32 v112, v68, v156
    s_mov_b32 s91, 19660800
    s_mov_b64 exec, s[76:77]
    v_lshrrev_b32 v81, 15, v90
    v_lshlrev_b16 v80, 2, v90
    v_add3_u32 v81, v81, v243, s91
    s_waitcnt lgkmcnt(6)
    v_add_u32 v106, v106, v138
    ds_write2st64_b32 v106, v80, v81 offset0:0 offset1:74
    s_mov_b64 exec, -1
    s_waitcnt vmcnt(13)
    v_bfe_u32 v70, v97, 12, 8
    v_and_or_b32 v71, v70, 28, v244
    v_add_u32 v70, v70, v245
    v_max_i32 v70, v70, v71
    ds_bpermute_b32 v113, v70, v157
    s_mov_b32 s91, 22937600
    s_mov_b64 exec, s[80:81]
    v_lshrrev_b32 v83, 15, v91
    v_lshlrev_b16 v82, 2, v91
    v_add3_u32 v83, v83, v243, s91
    s_waitcnt lgkmcnt(6)
    v_add_u32 v107, v107, v139
    ds_write2st64_b32 v107, v82, v83 offset0:0 offset1:74
    s_mov_b64 exec, -1
    s_waitcnt vmcnt(12)
    v_bfe_u32 v72, v98, 12, 8
    v_and_or_b32 v73, v72, 28, v244
    v_add_u32 v72, v72, v245
    v_max_i32 v72, v72, v73
    ds_bpermute_b32 v114, v72, v158
    s_mov_b32 s91, 9830400
    s_mov_b64 exec, s[66:67]
    v_lshrrev_b32 v83, 15, v95
    v_lshlrev_b16 v82, 2, v95
    v_add3_u32 v83, v83, v243, s91
    s_waitcnt lgkmcnt(6)
    v_add3_u32 v111, v111, v200, 64
    ds_write2st64_b32 v111, v82, v83 offset0:0 offset1:74
    s_mov_b64 exec, -1
    s_waitcnt vmcnt(11)
    v_bfe_u32 v74, v99, 12, 8
    v_and_or_b32 v75, v74, 28, v244
    v_add_u32 v74, v74, v245
    v_max_i32 v74, v74, v75
    ds_bpermute_b32 v115, v74, v159
    s_mov_b32 s91, 13107200
    s_mov_b64 exec, s[70:71]
    v_lshrrev_b32 v77, 15, v96
    v_lshlrev_b16 v76, 2, v96
    v_add3_u32 v77, v77, v243, s91
    s_waitcnt lgkmcnt(6)
    v_add3_u32 v112, v112, v136, 64
    ds_write2st64_b32 v112, v76, v77 offset0:0 offset1:74
    s_mov_b32 s91, 16384000
    s_mov_b64 exec, s[74:75]
    v_lshrrev_b32 v79, 15, v97
    v_lshlrev_b16 v78, 2, v97
    v_add3_u32 v79, v79, v243, s91
    s_waitcnt lgkmcnt(5)
    v_add3_u32 v113, v113, v137, 64
    ds_write2st64_b32 v113, v78, v79 offset0:0 offset1:74
    s_mov_b32 s91, 19660800
    s_mov_b64 exec, s[78:79]
    v_lshrrev_b32 v81, 15, v98
    v_lshlrev_b16 v80, 2, v98
    v_add3_u32 v81, v81, v243, s91
    s_waitcnt lgkmcnt(4)
    v_add3_u32 v114, v114, v138, 64
    ds_write2st64_b32 v114, v80, v81 offset0:0 offset1:74
    s_mov_b32 s91, 22937600
    s_mov_b64 exec, s[82:83]
    v_lshrrev_b32 v83, 15, v99
    v_lshlrev_b16 v82, 2, v99
    v_add3_u32 v83, v83, v243, s91
    s_waitcnt lgkmcnt(3)
    v_add3_u32 v115, v115, v139, 64
    ds_write2st64_b32 v115, v82, v83 offset0:0 offset1:74
    s_mov_b64 exec, -1
    s_waitcnt lgkmcnt(0)
    s_barrier
K_JOIN:
    ds_read_b128 v[84:87], v231 offset:0
    ds_read_b128 v[88:91], v231 offset:32
    ds_read_b128 v[92:95], v231 offset:64
    ds_read_b128 v[96:99], v231 offset:96
    ds_read_b128 v[100:103], v231 offset:128
    ds_read_b128 v[104:107], v231 offset:160
    ds_read_b128 v[108:111], v231 offset:192
    ds_read_b128 v[112:115], v231 offset:224
    s_add_u32 s86, s85, 31
    s_lshr_b32 s86, s86, 5
    s_cmp_eq_u32 s10, 0
    s_cbranch_scc1 K_STUB
    s_waitcnt vmcnt(5)
    v_mfma_f32_32x32x16_bf16 v[68:83], v[144:147], v[36:39], 0
    s_mov_b32 s10, 0
    v_mul_u32_u24 v221, 6, v221
    s_waitcnt vmcnt(4)
    v_mfma_f32_32x32x16_bf16 v[68:83], v[148:151], v[40:43], v[68:83]
    v_mov_b32 v160, 0
    v_mov_b32 v161, 0
    s_waitcnt vmcnt(3)
    v_mfma_f32_32x32x16_bf16 v[68:83], v[140:143], v[44:47], v[68:83]
    v_mov_b32 v162, 0
    s_waitcnt vmcnt(2)
    v_mfma_f32_32x32x16_bf16 v[68:83], v[124:127], v[48:51], v[68:83]
    v_min_u32 v221, 75000, v221
    v_mov_b32 v163, 0
K_FCHK:
    s_waitcnt vmcnt(1)
    v_xor_b32 v128, s46, v128
    v_xor_b32 v129, s46, v129
    v_xor_b32 v130, s46, v130
    v_xor_b32 v131, s46, v131
    v_or3_b32 v128, v128, v129, v130
    v_or_b32 v128, v128, v131
    v_cmp_ne_u32 s[52:53], 0, v128
    s_nop 0
    s_cmp_lg_u64 s[52:53], 0
    s_cbranch_scc1 K_FRETRY
K_FOK:
    s_waitcnt lgkmcnt(7)
    buffer_load_dword v84, v84, s[24:27], 0 offen sc1
    buffer_load_dword v85, v85, s[24:27], 0 offen sc1
    buffer_load_dword v86, v86, s[24:27], 0 offen sc1
    buffer_load_dword v87, v87, s[24:27], 0 offen sc1
    s_waitcnt lgkmcnt(6)
    buffer_load_dword v88, v88, s[24:27], 0 offen sc1
    buffer_load_dword v89, v89, s[24:27], 0 offen sc1
    buffer_load_dword v90, v90, s[24:27], 0 offen sc1
    buffer_load_dword v91, v91, s[24:27], 0 offen sc1
    s_waitcnt lgkmcnt(5)
    buffer_load_dword v92, v92, s[24:27], 0 offen sc1
    buffer_load_dword v93, v93, s[24:27], 0 offen sc1
    buffer_load_dword v94, v94, s[24:27], 0 offen sc1
    buffer_load_dword v95, v95, s[24:27], 0 offen sc1
    s_waitcnt lgkmcnt(4)
    buffer_load_dword v96, v96, s[24:27], 0 offen sc1
    buffer_load_dword v97, v97, s[24:27], 0 offen sc1
    buffer_load_dword v98, v98, s[24:27], 0 offen sc1
    buffer_load_dword v99, v99, s[24:27], 0 offen sc1
    buffer_load_dwordx4 v[136:139], v209, s[20:23], 0 offen
    v_mfma_f32_32x32x16_bf16 v[36:51], v[144:147], v[52:55], 0
    ds_read_u16_d16_hi v160, v221 offset:37504
    v_mfma_f32_32x32x16_bf16 v[36:51], v[148:151], v[56:59], v[36:51]
    ds_read_u16_d16_hi v161, v221 offset:37506
    ds_read_u16_d16_hi v162, v221 offset:37508
    v_mfma_f32_32x32x16_bf16 v[36:51], v[140:143], v[60:63], v[36:51]
    s_mov_b32 s91, 516
    v_mfma_f32_32x32x16_bf16 v[36:51], v[124:127], v[64:67], v[36:51]
    v_add_u32 v1, s85, v0
    v_mov_b32 v2, 50000
    v_mfma_f32_32x32x16_bf16 v[52:67], v[144:147], v[4:7], 0
    v_mov_b32 v3, 0x7ffffffc
    v_cmp_gt_u32 vcc, 580, v1
    v_mfma_f32_32x32x16_bf16 v[52:67], v[148:151], v[8:11], v[52:67]
    v_cmp_gt_u32 s[100:101], s91, v1
    v_mfma_f32_32x32x16_bf16 v[52:67], v[140:143], v[12:15], v[52:67]
    v_lshl_add_u32 v1, v1, 2, s93
    s_mov_b64 exec, vcc
    ds_write2st64_b32 v1, v2, v3 offset0:0 offset1:74
    s_mov_b64 exec, s[100:101]
    ds_write2st64_b32 v1, v2, v3 offset0:1 offset1:75
    s_mov_b64 exec, -1
    v_mfma_f32_32x32x16_bf16 v[52:67], v[124:127], v[16:19], v[52:67]
    v_add_u32 v2, s87, v248
    v_mfma_f32_32x32x16_bf16 v[4:19], v[144:147], v[20:23], 0
    s_mov_b64 exec, 0xff
    s_waitcnt lgkmcnt(2)
    ds_write_b128 v2, v[160:163]
    s_mov_b64 exec, -1
    v_lshrrev_b32 v3, 5, v0
    v_mfma_f32_32x32x16_bf16 v[4:19], v[148:151], v[24:27], v[4:19]
    v_lshl_add_u32 v246, v3, 13, s95
    v_mfma_f32_32x32x16_bf16 v[4:19], v[140:143], v[28:31], v[4:19]
    s_sub_u32 s91, s99, s95
    s_sub_u32 s91, s91, 12288
    s_lshl_b32 s91, s91, 7
    v_lshl_add_u32 v246, v246, 7, v222
    v_mfma_f32_32x32x16_bf16 v[4:19], v[124:127], v[32:35], v[4:19]
    v_mad_i32_i24 v247, s91, v3, v246
    v_mov_b32 v152, v68
    v_mov_b32 v153, v69
    v_mov_b32 v154, v70
    v_mov_b32 v155, v71
    v_mov_b32 v156, v36
    v_mov_b32 v157, v37
    v_mov_b32 v158, v38
    v_mov_b32 v159, v39
    v_lshlrev_b32 v2, 16, v241
    v_and_b32 v3, 0xffff0000, v241
    v_mov_b32 v144, 0
    v_mov_b32 v145, 0
    v_mov_b32 v146, 0
    v_mov_b32 v147, 0
    s_nop 1
    v_mfma_f32_32x32x16_bf16 v[20:35], v[144:147], v[144:147], 0
    v_cndmask_b32 v55, v55, v2, s[96:97]
    v_mul_f32 v52, s94, v52
    v_mul_f32 v53, s94, v53
    v_mul_f32 v54, s94, v54
    v_mul_f32 v55, s94, v55
    v_cvt_pk_bf16_f32 v68, 0, v52
    v_cvt_pk_bf16_f32 v69, 0, v53
    v_cvt_pk_bf16_f32 v70, 0, v54
    v_cvt_pk_bf16_f32 v71, 0, v55
    v_sub_f32 v52, v52, v68
    v_sub_f32 v53, v53, v69
    v_sub_f32 v54, v54, v70
    v_sub_f32 v55, v55, v71
    v_cvt_pk_bf16_f32 v124, v68, v52
    v_cvt_pk_bf16_f32 v125, v69, v53
    v_cvt_pk_bf16_f32 v126, v70, v54
    v_cvt_pk_bf16_f32 v127, v71, v55
    v_cndmask_b32 v7, v7, v3, s[96:97]
    v_mul_f32 v4, s94, v4
    v_mul_f32 v5, s94, v5
    v_mul_f32 v6, s94, v6
    v_mul_f32 v7, s94, v7
    v_cvt_pk_bf16_f32 v68, 0, v4
    v_cvt_pk_bf16_f32 v69, 0, v5
    v_cvt_pk_bf16_f32 v70, 0, v6
    v_cvt_pk_bf16_f32 v71, 0, v7
    v_sub_f32 v4, v4, v68
    v_sub_f32 v5, v5, v69
    v_sub_f32 v6, v6, v70
    v_sub_f32 v7, v7, v71
    v_cvt_pk_bf16_f32 v128, v68, v4
    v_cvt_pk_bf16_f32 v129, v69, v5
    v_cvt_pk_bf16_f32 v130, v70, v6
    v_cvt_pk_bf16_f32 v131, v71, v7
    v_mfma_f32_32x32x16_bf16 v[4:19], v[144:147], v[144:147], 0
K_NOSETUP:
    v_lshrrev_b32 v228, 1, v202
    v_and_b32 v222, 28, v203
    v_add_u32 v202, v202, v228
    v_lshl_add_u32 v228, v222, 2, s87
    ds_read_u16_d16_hi v218, v202 offset:37504
    ds_read_u16_d16_hi v219, v202 offset:37506
    ds_read_u16_d16_hi v220, v202 offset:37508
    ds_read_b128 v[160:163], v228
    ds_read2st64_b32 v[202:203], v232 offset0:1 offset1:75
    v_mov_b32 v144, 0
    v_mov_b32 v148, 0
    v_mov_b32 v145, 0
    v_mov_b32 v149, 0
    v_mov_b32 v146, 0
    v_mov_b32 v150, 0
    v_mov_b32 v147, 0
    v_mov_b32 v151, 0
    s_nop 0
    v_mfma_f32_32x32x16_bf16 v[36:51], v[144:147], v[144:147], 0
    s_waitcnt lgkmcnt(0)
    v_sub_f32 v160, v160, v218
    v_sub_f32 v161, v161, v219
    v_sub_f32 v162, v162, v220
    v_cvt_pk_bf16_f32 v205, v162, 1.0
    v_cvt_pk_bf16_f32 v204, v160, v161
    v_lshlrev_b32 v221, 16, v205
    v_add_u32 v223, v222, v236
    v_mul_f32 v221, v221, v221
    v_lshl_add_u32 v225, v222, 1, v237
    v_dot2_f32_bf16 v221, v204, v204, v221
    v_mov_b32 v224, v223
    v_mov_b32 v226, v225
    s_nop 0
    v_cvt_pk_bf16_f32 v221, v221, v221
    ds_write_b32 v223, v230
    ds_write_b32 v236, v221 offset:28
    ds_read_b128 v[140:143], v234 offset:0
    ds_write_b64 v225, v[204:205]
    v_and_b32 v208, s88, v203
    v_or_b32 v209, 16, v208
    v_lshrrev_b32 v228, 1, v202
    v_and_b32 v222, 28, v203
    v_add_u32 v202, v202, v228
    v_lshl_add_u32 v228, v222, 2, s87
    v_permlane32_swap_b32 v208, v209
    s_lshl_b32 s92, s3, 12
    s_add_u32 s92, s92, 113280
    v_and_b32 v2, 31, v0
    v_lshrrev_b32 v3, 5, v0
    v_mul_u32_u24 v1, 144, v3
    v_lshl_add_u32 v1, v2, 2, v1
    v_add_u32 v1, s92, v1
    v_and_b32 v2, 7, v0
    v_mul_u32_u24 v2, 144, v2
    v_add3_u32 v2, v2, v233, s92
    v_bfe_u32 v238, v0, 3, 1
    v_bfe_u32 v241, v0, 4, 1
    v_lshl_add_u32 v238, v238, 1, v241
    v_lshl_add_u32 v3, v238, 1, v3
    v_lshl_add_u32 v238, v3, 4, s87
    s_cmp_eq_u32 s90, s12
    s_cselect_b32 s91, s99, 0x8000
    s_cselect_b32 s96, -1, 0
    v_cmp_eq_u32 vcc, 6, v3
    v_mov_b32 v241, s91
    v_lshl_add_u32 v3, v3, 11, s95
    v_cndmask_b32 v3, v3, v241, vcc
    v_mul_u32_u24 v3, 6, v3
    s_mov_b64 s[28:29], s[44:45]
    s_mov_b32 s30, 0x186a00
    s_mov_b32 s31, 0x20000
    s_add_u32 s36, s44, 0x186a00
    s_addc_u32 s37, s45, 0
    s_mov_b32 s38, 0x124f8
    s_mov_b32 s39, 0x20000
    s_cmp_ge_u32 s3, 4
    s_cselect_b64 vcc, -1, 0
    s_waitcnt vmcnt(1) lgkmcnt(0)
    v_mfma_f32_32x32x16_bf16 v[52:67], v[132:135], v[120:123], v[84:99]
    v_mfma_f32_32x32x16_bf16 v[52:67], v[140:143], v[128:131], v[52:67]
    s_cmp_lg_u32 s89, 0
    s_cbranch_scc1 K_NOHR
    global_load_dword v242, v242, s[16:17]
    s_mov_b32 s91, 0
    buffer_load_dword v164, v246, s[40:43], s91 offen
    s_mov_b32 s91, 262144
    buffer_load_dword v165, v246, s[40:43], s91 offen
    s_mov_b32 s91, 524288
    buffer_load_dword v166, v247, s[40:43], s91 offen
    s_mov_b32 s91, 786432
    buffer_load_dword v167, v246, s[40:43], s91 offen
K_NOHR:
    s_sub_u32 s86, s86, 1
    s_cbranch_scc1 K_EMPTY
    s_sub_u32 s13, s85, 1
    s_bfe_u32 s13, s13, 0x20003
    s_sub_u32 s86, s86, 1
    s_cbranch_scc1 K_ONE
K_LOOP:
    s_cbranch_vccnz K_H0
    s_setprio 0
K_H0:
    buffer_load_dword v100, v100, s[24:27], 0 offen sc1
    buffer_load_dword v101, v101, s[24:27], 0 offen sc1
    buffer_load_dword v102, v102, s[24:27], 0 offen sc1
    buffer_load_dword v103, v103, s[24:27], 0 offen sc1
    buffer_load_dword v104, v104, s[24:27], 0 offen sc1
    buffer_load_dword v105, v105, s[24:27], 0 offen sc1
    buffer_load_dword v106, v106, s[24:27], 0 offen sc1
    buffer_load_dword v107, v107, s[24:27], 0 offen sc1
    buffer_load_dword v108, v108, s[24:27], 0 offen sc1
    buffer_load_dword v109, v109, s[24:27], 0 offen sc1
    buffer_load_dword v110, v110, s[24:27], 0 offen sc1
    buffer_load_dword v111, v111, s[24:27], 0 offen sc1
    buffer_load_dword v112, v112, s[24:27], 0 offen sc1
    buffer_load_dword v113, v113, s[24:27], 0 offen sc1
    buffer_load_dword v114, v114, s[24:27], 0 offen sc1
    buffer_load_dword v115, v115, s[24:27], 0 offen sc1
    s_setprio 0
    v_exp_f32 v68, v52
    s_setprio 1
    v_mfma_f32_32x32x16_bf16 v[4:19], v[144:147], v[36:39], v[4:19]
    v_exp_f32 v69, v53
    v_exp_f32 v70, v54
    v_exp_f32 v71, v55
    v_mfma_f32_32x32x16_bf16 v[4:19], v[148:151], v[44:47], v[4:19]
    v_exp_f32 v72, v56
    v_exp_f32 v73, v57
    v_exp_f32 v74, v58
    v_exp_f32 v75, v59
    v_lshlrev_b32 v36, 16, v84
    v_lshlrev_b32 v37, 16, v85
    v_exp_f32 v76, v60
    v_lshlrev_b32 v38, 16, v86
    v_lshlrev_b32 v39, 16, v87
    v_exp_f32 v77, v61
    v_lshlrev_b32 v40, 16, v88
    v_lshlrev_b32 v41, 16, v89
    v_exp_f32 v78, v62
    v_lshlrev_b32 v42, 16, v90
    v_lshlrev_b32 v43, 16, v91
    v_exp_f32 v79, v63
    v_lshlrev_b32 v44, 16, v92
    v_lshlrev_b32 v45, 16, v93
    v_exp_f32 v80, v64
    s_setprio 2
    v_lshlrev_b32 v46, 16, v94
    v_lshlrev_b32 v47, 16, v95
    v_exp_f32 v81, v65
    v_lshlrev_b32 v48, 16, v96
    v_lshlrev_b32 v49, 16, v97
    v_exp_f32 v82, v66
    v_lshlrev_b32 v50, 16, v98
    v_lshlrev_b32 v51, 16, v99
    v_exp_f32 v83, v67
    v_pk_add_f32 v[68:69], v[68:69], 1.0 op_sel_hi:[1,0]
    v_pk_add_f32 v[70:71], v[70:71], 1.0 op_sel_hi:[1,0]
    v_pk_add_f32 v[72:73], v[72:73], 1.0 op_sel_hi:[1,0]
    v_pk_add_f32 v[74:75], v[74:75], 1.0 op_sel_hi:[1,0]
    v_pk_add_f32 v[76:77], v[76:77], 1.0 op_sel_hi:[1,0]
    v_pk_add_f32 v[78:79], v[78:79], 1.0 op_sel_hi:[1,0]
    v_pk_add_f32 v[80:81], v[80:81], 1.0 op_sel_hi:[1,0]
    v_pk_add_f32 v[82:83], v[82:83], 1.0 op_sel_hi:[1,0]
    v_rcp_f32 v68, v68
    v_mfma_f32_32x32x16_bf16 v[36:51], v[132:135], v[116:119], v[36:51]
    v_rcp_f32 v69, v69
    v_rcp_f32 v70, v70
    v_rcp_f32 v71, v71
    v_rcp_f32 v72, v72
    v_mfma_f32_32x32x16_bf16 v[36:51], v[140:143], v[124:127], v[36:51]
    v_rcp_f32 v73, v73
    v_rcp_f32 v74, v74
    v_rcp_f32 v75, v75
    s_setprio 3
    v_rcp_f32 v76, v76
    v_rcp_f32 v77, v77
    v_rcp_f32 v78, v78
    v_rcp_f32 v79, v79
    v_rcp_f32 v80, v80
    v_rcp_f32 v81, v81
    v_rcp_f32 v82, v82
    v_rcp_f32 v83, v83
    v_pk_mul_f32 v[52:53], v[52:53], v[68:69]
    v_pk_mul_f32 v[54:55], v[54:55], v[70:71]
    v_pk_mul_f32 v[56:57], v[56:57], v[72:73]
    v_pk_mul_f32 v[58:59], v[58:59], v[74:75]
    v_pk_mul_f32 v[60:61], v[60:61], v[76:77]
    v_pk_mul_f32 v[62:63], v[62:63], v[78:79]
    v_pk_mul_f32 v[64:65], v[64:65], v[80:81]
    v_pk_mul_f32 v[66:67], v[66:67], v[82:83]
    v_cvt_pk_bf16_f32 v52, v52, v53
    v_cvt_pk_bf16_f32 v53, v54, v55
    v_cvt_pk_bf16_f32 v54, v56, v57
    v_cvt_pk_bf16_f32 v55, v58, v59
    v_cvt_pk_bf16_f32 v60, v60, v61
    v_cvt_pk_bf16_f32 v61, v62, v63
    v_cvt_pk_bf16_f32 v62, v64, v65
    v_cvt_pk_bf16_f32 v63, v66, v67
    s_setprio 0
    buffer_load_dwordx4 v[132:135], v208, s[20:23], 0 offen
    ds_read_b64_tr_b16 v[144:145], v235 offset:0
    ds_read_b64_tr_b16 v[146:147], v235 offset:512
    ds_read_b64_tr_b16 v[148:149], v235 offset:1024
    ds_read_b64_tr_b16 v[150:151], v235 offset:1536
    ds_read_b128 v[140:143], v234 offset:1024
    ds_read_u16_d16_hi v218, v202 offset:37504
    ds_read_u16_d16_hi v219, v202 offset:37506
    ds_read_u16_d16_hi v220, v202 offset:37508
    ds_read_b128 v[160:163], v228
    ds_read_b128 v[84:87], v231 offset:256
    ds_read_b128 v[88:91], v231 offset:288
    ds_read_b128 v[92:95], v231 offset:320
    ds_read_b128 v[96:99], v231 offset:352
    s_sub_u32 s86, s86, 1
    s_waitcnt lgkmcnt(4)
    v_exp_f32 v68, v36
    s_setprio 1
    v_mfma_f32_32x32x16_bf16 v[20:35], v[144:147], v[52:55], v[20:35]
    v_exp_f32 v69, v37
    v_exp_f32 v70, v38
    v_exp_f32 v71, v39
    v_mfma_f32_32x32x16_bf16 v[20:35], v[148:151], v[60:63], v[20:35]
    v_exp_f32 v72, v40
    v_exp_f32 v73, v41
    v_sub_f32 v160, v160, v218
    v_exp_f32 v74, v42
    v_sub_f32 v161, v161, v219
    v_exp_f32 v75, v43
    v_sub_f32 v162, v162, v220
    v_exp_f32 v76, v44
    v_cvt_pk_bf16_f32 v205, v162, 1.0
    v_exp_f32 v77, v45
    v_cvt_pk_bf16_f32 v204, v160, v161
    v_exp_f32 v78, v46
    v_lshlrev_b32 v221, 16, v205
    v_exp_f32 v79, v47
    v_add_u32 v223, v222, v236
    v_exp_f32 v80, v48
    s_setprio 2
    v_mul_f32 v221, v221, v221
    v_exp_f32 v81, v49
    v_lshl_add_u32 v225, v222, 1, v237
    v_exp_f32 v82, v50
    v_dot2_f32_bf16 v221, v204, v204, v221
    v_exp_f32 v83, v51
    v_pk_add_f32 v[68:69], v[68:69], 1.0 op_sel_hi:[1,0]
    v_pk_add_f32 v[70:71], v[70:71], 1.0 op_sel_hi:[1,0]
    v_pk_add_f32 v[72:73], v[72:73], 1.0 op_sel_hi:[1,0]
    v_pk_add_f32 v[74:75], v[74:75], 1.0 op_sel_hi:[1,0]
    v_pk_add_f32 v[76:77], v[76:77], 1.0 op_sel_hi:[1,0]
    v_pk_add_f32 v[78:79], v[78:79], 1.0 op_sel_hi:[1,0]
    v_pk_add_f32 v[80:81], v[80:81], 1.0 op_sel_hi:[1,0]
    v_pk_add_f32 v[82:83], v[82:83], 1.0 op_sel_hi:[1,0]
    v_rcp_f32 v68, v68
    v_rcp_f32 v69, v69
    v_rcp_f32 v70, v70
    v_rcp_f32 v71, v71
    v_rcp_f32 v72, v72
    s_waitcnt vmcnt(1) lgkmcnt(0)
    v_mfma_f32_32x32x16_bf16 v[52:67], v[136:139], v[120:123], v[100:115]
    v_rcp_f32 v73, v73
    v_rcp_f32 v74, v74
    v_rcp_f32 v75, v75
    s_setprio 3
    v_rcp_f32 v76, v76
    v_mfma_f32_32x32x16_bf16 v[52:67], v[140:143], v[128:131], v[52:67]
    v_rcp_f32 v77, v77
    v_rcp_f32 v78, v78
    v_rcp_f32 v79, v79
    v_rcp_f32 v80, v80
    v_cvt_pk_bf16_f32 v221, v221, v221
    v_rcp_f32 v81, v81
    v_rcp_f32 v82, v82
    v_rcp_f32 v83, v83
    v_pk_mul_f32 v[36:37], v[36:37], v[68:69]
    v_pk_mul_f32 v[38:39], v[38:39], v[70:71]
    v_pk_mul_f32 v[40:41], v[40:41], v[72:73]
    v_pk_mul_f32 v[42:43], v[42:43], v[74:75]
    v_pk_mul_f32 v[44:45], v[44:45], v[76:77]
    v_pk_mul_f32 v[46:47], v[46:47], v[78:79]
    v_pk_mul_f32 v[48:49], v[48:49], v[80:81]
    v_pk_mul_f32 v[50:51], v[50:51], v[82:83]
    v_cvt_pk_bf16_f32 v36, v36, v37
    v_cvt_pk_bf16_f32 v37, v38, v39
    v_cvt_pk_bf16_f32 v38, v40, v41
    v_cvt_pk_bf16_f32 v39, v42, v43
    v_cvt_pk_bf16_f32 v44, v44, v45
    v_cvt_pk_bf16_f32 v45, v46, v47
    v_cvt_pk_bf16_f32 v46, v48, v49
    v_cvt_pk_bf16_f32 v47, v50, v51
    s_cbranch_scc1 K_LAST1
    s_cbranch_vccnz K_H1
    s_setprio 0
K_H1:
    ds_write_b32 v224, v206
    ds_write_b32 v223, v230
    ds_write_b32 v236, v221 offset:28
    buffer_load_dword v84, v84, s[24:27], 0 offen sc1
    buffer_load_dword v85, v85, s[24:27], 0 offen sc1
    buffer_load_dword v86, v86, s[24:27], 0 offen sc1
    buffer_load_dword v87, v87, s[24:27], 0 offen sc1
    buffer_load_dword v88, v88, s[24:27], 0 offen sc1
    buffer_load_dword v89, v89, s[24:27], 0 offen sc1
    buffer_load_dword v90, v90, s[24:27], 0 offen sc1
    buffer_load_dword v91, v91, s[24:27], 0 offen sc1
    buffer_load_dword v92, v92, s[24:27], 0 offen sc1
    buffer_load_dword v93, v93, s[24:27], 0 offen sc1
    buffer_load_dword v94, v94, s[24:27], 0 offen sc1
    buffer_load_dword v95, v95, s[24:27], 0 offen sc1
    buffer_load_dword v96, v96, s[24:27], 0 offen sc1
    buffer_load_dword v97, v97, s[24:27], 0 offen sc1
    buffer_load_dword v98, v98, s[24:27], 0 offen sc1
    buffer_load_dword v99, v99, s[24:27], 0 offen sc1
    s_setprio 0
    v_exp_f32 v68, v52
    s_setprio 1
    v_mfma_f32_32x32x16_bf16 v[4:19], v[144:147], v[36:39], v[4:19]
    v_exp_f32 v69, v53
    v_exp_f32 v70, v54
    v_exp_f32 v71, v55
    v_mfma_f32_32x32x16_bf16 v[4:19], v[148:151], v[44:47], v[4:19]
    v_exp_f32 v72, v56
    v_exp_f32 v73, v57
    v_exp_f32 v74, v58
    v_exp_f32 v75, v59
    v_lshlrev_b32 v36, 16, v100
    v_lshlrev_b32 v37, 16, v101
    v_exp_f32 v76, v60
    v_lshlrev_b32 v38, 16, v102
    v_lshlrev_b32 v39, 16, v103
    v_exp_f32 v77, v61
    v_lshlrev_b32 v40, 16, v104
    v_lshlrev_b32 v41, 16, v105
    v_exp_f32 v78, v62
    v_lshlrev_b32 v42, 16, v106
    v_lshlrev_b32 v43, 16, v107
    v_exp_f32 v79, v63
    v_lshlrev_b32 v44, 16, v108
    v_lshlrev_b32 v45, 16, v109
    v_exp_f32 v80, v64
    s_setprio 2
    v_lshlrev_b32 v46, 16, v110
    v_lshlrev_b32 v47, 16, v111
    v_exp_f32 v81, v65
    v_lshlrev_b32 v48, 16, v112
    v_lshlrev_b32 v49, 16, v113
    v_exp_f32 v82, v66
    v_lshlrev_b32 v50, 16, v114
    v_lshlrev_b32 v51, 16, v115
    v_exp_f32 v83, v67
    v_pk_add_f32 v[68:69], v[68:69], 1.0 op_sel_hi:[1,0]
    v_pk_add_f32 v[70:71], v[70:71], 1.0 op_sel_hi:[1,0]
    v_pk_add_f32 v[72:73], v[72:73], 1.0 op_sel_hi:[1,0]
    v_pk_add_f32 v[74:75], v[74:75], 1.0 op_sel_hi:[1,0]
    v_pk_add_f32 v[76:77], v[76:77], 1.0 op_sel_hi:[1,0]
    v_pk_add_f32 v[78:79], v[78:79], 1.0 op_sel_hi:[1,0]
    v_pk_add_f32 v[80:81], v[80:81], 1.0 op_sel_hi:[1,0]
    v_pk_add_f32 v[82:83], v[82:83], 1.0 op_sel_hi:[1,0]
    v_rcp_f32 v68, v68
    v_mfma_f32_32x32x16_bf16 v[36:51], v[136:139], v[116:119], v[36:51]
    v_rcp_f32 v69, v69
    v_rcp_f32 v70, v70
    v_rcp_f32 v71, v71
    v_rcp_f32 v72, v72
    v_mfma_f32_32x32x16_bf16 v[36:51], v[140:143], v[124:127], v[36:51]
    v_rcp_f32 v73, v73
    v_rcp_f32 v74, v74
    v_rcp_f32 v75, v75
    s_setprio 3
    v_rcp_f32 v76, v76
    v_rcp_f32 v77, v77
    v_rcp_f32 v78, v78
    v_rcp_f32 v79, v79
    v_rcp_f32 v80, v80
    v_rcp_f32 v81, v81
    v_rcp_f32 v82, v82
    v_rcp_f32 v83, v83
    v_pk_mul_f32 v[52:53], v[52:53], v[68:69]
    v_pk_mul_f32 v[54:55], v[54:55], v[70:71]
    v_pk_mul_f32 v[56:57], v[56:57], v[72:73]
    v_pk_mul_f32 v[58:59], v[58:59], v[74:75]
    v_pk_mul_f32 v[60:61], v[60:61], v[76:77]
    v_pk_mul_f32 v[62:63], v[62:63], v[78:79]
    v_pk_mul_f32 v[64:65], v[64:65], v[80:81]
    v_pk_mul_f32 v[66:67], v[66:67], v[82:83]
    v_cvt_pk_bf16_f32 v52, v52, v53
    v_cvt_pk_bf16_f32 v53, v54, v55
    v_cvt_pk_bf16_f32 v54, v56, v57
    v_cvt_pk_bf16_f32 v55, v58, v59
    v_cvt_pk_bf16_f32 v60, v60, v61
    v_cvt_pk_bf16_f32 v61, v62, v63
    v_cvt_pk_bf16_f32 v62, v64, v65
    v_cvt_pk_bf16_f32 v63, v66, v67
    s_setprio 0
    buffer_load_dwordx4 v[136:139], v209, s[20:23], 0 offen
    ds_read_b64_tr_b16 v[144:145], v235 offset:2048
    ds_read_b64_tr_b16 v[146:147], v235 offset:2560
    ds_read_b64_tr_b16 v[148:149], v235 offset:3072
    ds_read_b64_tr_b16 v[150:151], v235 offset:3584
    ds_read_b128 v[140:143], v234 offset:0
    ds_read2st64_b32 v[202:203], v232 offset0:2 offset1:76
    ds_read_b128 v[100:103], v231 offset:384
    ds_read_b128 v[104:107], v231 offset:416
    ds_read_b128 v[108:111], v231 offset:448
    ds_read_b128 v[112:115], v231 offset:480
    ds_write_b64 v226, v[206:207]
    ds_write_b64 v225, v[204:205]
    s_sub_u32 s86, s86, 1
    s_waitcnt lgkmcnt(6)
    v_exp_f32 v68, v36
    s_setprio 1
    v_mfma_f32_32x32x16_bf16 v[20:35], v[144:147], v[52:55], v[20:35]
    v_exp_f32 v69, v37
    v_exp_f32 v70, v38
    v_exp_f32 v71, v39
    v_mfma_f32_32x32x16_bf16 v[20:35], v[148:151], v[60:63], v[20:35]
    v_exp_f32 v72, v40
    v_and_b32 v208, s88, v203
    v_exp_f32 v73, v41
    v_or_b32 v209, 16, v208
    v_exp_f32 v74, v42
    v_mov_b32 v224, v223
    v_exp_f32 v75, v43
    v_mov_b32 v226, v225
    v_exp_f32 v76, v44
    v_permlane32_swap_b32 v208, v209
    v_exp_f32 v77, v45
    v_lshrrev_b32 v228, 1, v202
    v_exp_f32 v78, v46
    v_and_b32 v222, 28, v203
    v_exp_f32 v79, v47
    v_add_u32 v202, v202, v228
    v_exp_f32 v80, v48
    s_setprio 2
    v_lshl_add_u32 v228, v222, 2, s87
    v_exp_f32 v81, v49
    v_add_u32 v231, 0x100, v231
    v_exp_f32 v82, v50
    v_add_u32 v232, 0x100, v232
    v_exp_f32 v83, v51
    v_pk_add_f32 v[68:69], v[68:69], 1.0 op_sel_hi:[1,0]
    v_pk_add_f32 v[70:71], v[70:71], 1.0 op_sel_hi:[1,0]
    v_pk_add_f32 v[72:73], v[72:73], 1.0 op_sel_hi:[1,0]
    v_pk_add_f32 v[74:75], v[74:75], 1.0 op_sel_hi:[1,0]
    v_pk_add_f32 v[76:77], v[76:77], 1.0 op_sel_hi:[1,0]
    v_pk_add_f32 v[78:79], v[78:79], 1.0 op_sel_hi:[1,0]
    v_pk_add_f32 v[80:81], v[80:81], 1.0 op_sel_hi:[1,0]
    v_pk_add_f32 v[82:83], v[82:83], 1.0 op_sel_hi:[1,0]
    v_rcp_f32 v68, v68
    v_rcp_f32 v69, v69
    v_rcp_f32 v70, v70
    v_rcp_f32 v71, v71
    v_rcp_f32 v72, v72
    s_waitcnt vmcnt(1) lgkmcnt(0)
    v_mfma_f32_32x32x16_bf16 v[52:67], v[132:135], v[120:123], v[84:99]
    v_rcp_f32 v73, v73
    v_rcp_f32 v74, v74
    v_rcp_f32 v75, v75
    s_setprio 3
    v_rcp_f32 v76, v76
    v_mfma_f32_32x32x16_bf16 v[52:67], v[140:143], v[128:131], v[52:67]
    v_rcp_f32 v77, v77
    v_rcp_f32 v78, v78
    v_rcp_f32 v79, v79
    v_rcp_f32 v80, v80
    v_rcp_f32 v81, v81
    v_rcp_f32 v82, v82
    v_rcp_f32 v83, v83
    v_pk_mul_f32 v[36:37], v[36:37], v[68:69]
    v_pk_mul_f32 v[38:39], v[38:39], v[70:71]
    v_pk_mul_f32 v[40:41], v[40:41], v[72:73]
    v_pk_mul_f32 v[42:43], v[42:43], v[74:75]
    v_pk_mul_f32 v[44:45], v[44:45], v[76:77]
    v_pk_mul_f32 v[46:47], v[46:47], v[78:79]
    v_pk_mul_f32 v[48:49], v[48:49], v[80:81]
    v_pk_mul_f32 v[50:51], v[50:51], v[82:83]
    v_cvt_pk_bf16_f32 v36, v36, v37
    v_cvt_pk_bf16_f32 v37, v38, v39
    v_cvt_pk_bf16_f32 v38, v40, v41
    v_cvt_pk_bf16_f32 v39, v42, v43
    v_cvt_pk_bf16_f32 v44, v44, v45
    v_cvt_pk_bf16_f32 v45, v46, v47
    v_cvt_pk_bf16_f32 v46, v48, v49
    v_cvt_pk_bf16_f32 v47, v50, v51
    s_cbranch_scc0 K_LOOP
K_LAST0:
    s_setprio 0
    v_exp_f32 v68, v52
    s_setprio 2
    v_mfma_f32_32x32x16_bf16 v[4:19], v[144:147], v[36:39], v[4:19]
    v_exp_f32 v69, v53
    v_exp_f32 v70, v54
    v_exp_f32 v71, v55
    v_mfma_f32_32x32x16_bf16 v[4:19], v[148:151], v[44:47], v[4:19]
    v_lshlrev_b32 v36, 16, v84
    v_lshlrev_b32 v37, 16, v85
    v_lshlrev_b32 v38, 16, v86
    v_lshlrev_b32 v39, 16, v87
    v_lshlrev_b32 v40, 16, v88
    v_lshlrev_b32 v41, 16, v89
    v_lshlrev_b32 v42, 16, v90
    v_lshlrev_b32 v43, 16, v91
    v_lshlrev_b32 v44, 16, v92
    v_lshlrev_b32 v45, 16, v93
    v_lshlrev_b32 v46, 16, v94
    v_lshlrev_b32 v47, 16, v95
    v_lshlrev_b32 v48, 16, v96
    v_lshlrev_b32 v49, 16, v97
    v_lshlrev_b32 v50, 16, v98
    v_lshlrev_b32 v51, 16, v99
    v_pk_add_f32 v[68:69], v[68:69], 1.0 op_sel_hi:[1,0]
    v_pk_add_f32 v[70:71], v[70:71], 1.0 op_sel_hi:[1,0]
    v_rcp_f32 v68, v68
    v_mfma_f32_32x32x16_bf16 v[36:51], v[132:135], v[116:119], v[36:51]
    v_rcp_f32 v69, v69
    v_rcp_f32 v70, v70
    v_rcp_f32 v71, v71
    v_mfma_f32_32x32x16_bf16 v[36:51], v[140:143], v[124:127], v[36:51]
    ds_read_b64_tr_b16 v[144:145], v235 offset:0
    ds_read_b64_tr_b16 v[146:147], v235 offset:512
    ds_read_b64_tr_b16 v[148:149], v235 offset:1024
    ds_read_b64_tr_b16 v[150:151], v235 offset:1536
    v_pk_mul_f32 v[52:53], v[52:53], v[68:69]
    v_pk_mul_f32 v[54:55], v[54:55], v[70:71]
    s_cmp_lt_u32 s13, 1
    s_cbranch_scc1 K_LA0
    v_exp_f32 v72, v56
    v_exp_f32 v73, v57
    v_exp_f32 v74, v58
    v_exp_f32 v75, v59
    v_pk_add_f32 v[72:73], v[72:73], 1.0 op_sel_hi:[1,0]
    v_pk_add_f32 v[74:75], v[74:75], 1.0 op_sel_hi:[1,0]
    v_rcp_f32 v72, v72
    v_rcp_f32 v73, v73
    v_rcp_f32 v74, v74
    v_rcp_f32 v75, v75
    v_pk_mul_f32 v[56:57], v[56:57], v[72:73]
    v_pk_mul_f32 v[58:59], v[58:59], v[74:75]
    s_cmp_lt_u32 s13, 2
    s_cbranch_scc1 K_LA0
    v_exp_f32 v76, v60
    v_exp_f32 v77, v61
    v_exp_f32 v78, v62
    v_exp_f32 v79, v63
    v_pk_add_f32 v[76:77], v[76:77], 1.0 op_sel_hi:[1,0]
    v_pk_add_f32 v[78:79], v[78:79], 1.0 op_sel_hi:[1,0]
    v_rcp_f32 v76, v76
    v_rcp_f32 v77, v77
    v_rcp_f32 v78, v78
    v_rcp_f32 v79, v79
    v_pk_mul_f32 v[60:61], v[60:61], v[76:77]
    v_pk_mul_f32 v[62:63], v[62:63], v[78:79]
    s_cmp_lt_u32 s13, 3
    s_cbranch_scc1 K_LA0
    v_exp_f32 v80, v64
    v_exp_f32 v81, v65
    v_exp_f32 v82, v66
    v_exp_f32 v83, v67
    v_pk_add_f32 v[80:81], v[80:81], 1.0 op_sel_hi:[1,0]
    v_pk_add_f32 v[82:83], v[82:83], 1.0 op_sel_hi:[1,0]
    v_rcp_f32 v80, v80
    v_rcp_f32 v81, v81
    v_rcp_f32 v82, v82
    v_rcp_f32 v83, v83
    v_pk_mul_f32 v[64:65], v[64:65], v[80:81]
    v_pk_mul_f32 v[66:67], v[66:67], v[82:83]
K_LA0:
    v_cvt_pk_bf16_f32 v52, v52, v53
    v_cvt_pk_bf16_f32 v53, v54, v55
    v_cvt_pk_bf16_f32 v54, v56, v57
    v_cvt_pk_bf16_f32 v55, v58, v59
    v_cvt_pk_bf16_f32 v60, v60, v61
    v_cvt_pk_bf16_f32 v61, v62, v63
    v_cvt_pk_bf16_f32 v62, v64, v65
    v_cvt_pk_bf16_f32 v63, v66, v67
    s_waitcnt lgkmcnt(0)
    v_mfma_f32_32x32x16_bf16 v[20:35], v[144:147], v[52:55], v[20:35]
    v_exp_f32 v68, v36
    v_exp_f32 v69, v37
    v_exp_f32 v70, v38
    v_mfma_f32_32x32x16_bf16 v[20:35], v[148:151], v[60:63], v[20:35]
    v_exp_f32 v71, v39
    v_pk_add_f32 v[68:69], v[68:69], 1.0 op_sel_hi:[1,0]
    v_pk_add_f32 v[70:71], v[70:71], 1.0 op_sel_hi:[1,0]
    v_rcp_f32 v68, v68
    v_rcp_f32 v69, v69
    v_rcp_f32 v70, v70
    v_rcp_f32 v71, v71
    v_pk_mul_f32 v[36:37], v[36:37], v[68:69]
    v_pk_mul_f32 v[38:39], v[38:39], v[70:71]
    s_cmp_lt_u32 s13, 1
    s_cbranch_scc1 K_LB
    v_exp_f32 v72, v40
    v_exp_f32 v73, v41
    v_exp_f32 v74, v42
    v_exp_f32 v75, v43
    v_pk_add_f32 v[72:73], v[72:73], 1.0 op_sel_hi:[1,0]
    v_pk_add_f32 v[74:75], v[74:75], 1.0 op_sel_hi:[1,0]
    v_rcp_f32 v72, v72
    v_rcp_f32 v73, v73
    v_rcp_f32 v74, v74
    v_rcp_f32 v75, v75
    v_pk_mul_f32 v[40:41], v[40:41], v[72:73]
    v_pk_mul_f32 v[42:43], v[42:43], v[74:75]
    s_cmp_lt_u32 s13, 2
    s_cbranch_scc1 K_LB
    v_exp_f32 v76, v44
    v_exp_f32 v77, v45
    v_exp_f32 v78, v46
    v_exp_f32 v79, v47
    v_pk_add_f32 v[76:77], v[76:77], 1.0 op_sel_hi:[1,0]
    v_pk_add_f32 v[78:79], v[78:79], 1.0 op_sel_hi:[1,0]
    v_rcp_f32 v76, v76
    v_rcp_f32 v77, v77
    v_rcp_f32 v78, v78
    v_rcp_f32 v79, v79
    v_pk_mul_f32 v[44:45], v[44:45], v[76:77]
    v_pk_mul_f32 v[46:47], v[46:47], v[78:79]
    s_cmp_lt_u32 s13, 3
    s_cbranch_scc1 K_LB
    v_exp_f32 v80, v48
    v_exp_f32 v81, v49
    v_exp_f32 v82, v50
    v_exp_f32 v83, v51
    v_pk_add_f32 v[80:81], v[80:81], 1.0 op_sel_hi:[1,0]
    v_pk_add_f32 v[82:83], v[82:83], 1.0 op_sel_hi:[1,0]
    v_rcp_f32 v80, v80
    v_rcp_f32 v81, v81
    v_rcp_f32 v82, v82
    v_rcp_f32 v83, v83
    v_pk_mul_f32 v[48:49], v[48:49], v[80:81]
    v_pk_mul_f32 v[50:51], v[50:51], v[82:83]
    s_branch K_LB
K_LAST1:
    s_setprio 0
    v_exp_f32 v68, v52
    s_setprio 2
    v_mfma_f32_32x32x16_bf16 v[4:19], v[144:147], v[36:39], v[4:19]
    v_exp_f32 v69, v53
    v_exp_f32 v70, v54
    v_exp_f32 v71, v55
    v_mfma_f32_32x32x16_bf16 v[4:19], v[148:151], v[44:47], v[4:19]
    v_lshlrev_b32 v36, 16, v100
    v_lshlrev_b32 v37, 16, v101
    v_lshlrev_b32 v38, 16, v102
    v_lshlrev_b32 v39, 16, v103
    v_lshlrev_b32 v40, 16, v104
    v_lshlrev_b32 v41, 16, v105
    v_lshlrev_b32 v42, 16, v106
    v_lshlrev_b32 v43, 16, v107
    v_lshlrev_b32 v44, 16, v108
    v_lshlrev_b32 v45, 16, v109
    v_lshlrev_b32 v46, 16, v110
    v_lshlrev_b32 v47, 16, v111
    v_lshlrev_b32 v48, 16, v112
    v_lshlrev_b32 v49, 16, v113
    v_lshlrev_b32 v50, 16, v114
    v_lshlrev_b32 v51, 16, v115
    v_pk_add_f32 v[68:69], v[68:69], 1.0 op_sel_hi:[1,0]
    v_pk_add_f32 v[70:71], v[70:71], 1.0 op_sel_hi:[1,0]
    v_rcp_f32 v68, v68
    v_mfma_f32_32x32x16_bf16 v[36:51], v[136:139], v[116:119], v[36:51]
    v_rcp_f32 v69, v69
    v_rcp_f32 v70, v70
    v_rcp_f32 v71, v71
    v_mfma_f32_32x32x16_bf16 v[36:51], v[140:143], v[124:127], v[36:51]
    ds_read_b64_tr_b16 v[144:145], v235 offset:2048
    ds_read_b64_tr_b16 v[146:147], v235 offset:2560
    ds_read_b64_tr_b16 v[148:149], v235 offset:3072
    ds_read_b64_tr_b16 v[150:151], v235 offset:3584
    v_pk_mul_f32 v[52:53], v[52:53], v[68:69]
    v_pk_mul_f32 v[54:55], v[54:55], v[70:71]
    s_cmp_lt_u32 s13, 1
    s_cbranch_scc1 K_LA1
    v_exp_f32 v72, v56
    v_exp_f32 v73, v57
    v_exp_f32 v74, v58
    v_exp_f32 v75, v59
    v_pk_add_f32 v[72:73], v[72:73], 1.0 op_sel_hi:[1,0]
    v_pk_add_f32 v[74:75], v[74:75], 1.0 op_sel_hi:[1,0]
    v_rcp_f32 v72, v72
    v_rcp_f32 v73, v73
    v_rcp_f32 v74, v74
    v_rcp_f32 v75, v75
    v_pk_mul_f32 v[56:57], v[56:57], v[72:73]
    v_pk_mul_f32 v[58:59], v[58:59], v[74:75]
    s_cmp_lt_u32 s13, 2
    s_cbranch_scc1 K_LA1
    v_exp_f32 v76, v60
    v_exp_f32 v77, v61
    v_exp_f32 v78, v62
    v_exp_f32 v79, v63
    v_pk_add_f32 v[76:77], v[76:77], 1.0 op_sel_hi:[1,0]
    v_pk_add_f32 v[78:79], v[78:79], 1.0 op_sel_hi:[1,0]
    v_rcp_f32 v76, v76
    v_rcp_f32 v77, v77
    v_rcp_f32 v78, v78
    v_rcp_f32 v79, v79
    v_pk_mul_f32 v[60:61], v[60:61], v[76:77]
    v_pk_mul_f32 v[62:63], v[62:63], v[78:79]
    s_cmp_lt_u32 s13, 3
    s_cbranch_scc1 K_LA1
    v_exp_f32 v80, v64
    v_exp_f32 v81, v65
    v_exp_f32 v82, v66
    v_exp_f32 v83, v67
    v_pk_add_f32 v[80:81], v[80:81], 1.0 op_sel_hi:[1,0]
    v_pk_add_f32 v[82:83], v[82:83], 1.0 op_sel_hi:[1,0]
    v_rcp_f32 v80, v80
    v_rcp_f32 v81, v81
    v_rcp_f32 v82, v82
    v_rcp_f32 v83, v83
    v_pk_mul_f32 v[64:65], v[64:65], v[80:81]
    v_pk_mul_f32 v[66:67], v[66:67], v[82:83]
K_LA1:
    v_cvt_pk_bf16_f32 v52, v52, v53
    v_cvt_pk_bf16_f32 v53, v54, v55
    v_cvt_pk_bf16_f32 v54, v56, v57
    v_cvt_pk_bf16_f32 v55, v58, v59
    v_cvt_pk_bf16_f32 v60, v60, v61
    v_cvt_pk_bf16_f32 v61, v62, v63
    v_cvt_pk_bf16_f32 v62, v64, v65
    v_cvt_pk_bf16_f32 v63, v66, v67
    s_waitcnt lgkmcnt(0)
    v_mfma_f32_32x32x16_bf16 v[20:35], v[144:147], v[52:55], v[20:35]
    v_exp_f32 v68, v36
    v_exp_f32 v69, v37
    v_exp_f32 v70, v38
    v_mfma_f32_32x32x16_bf16 v[20:35], v[148:151], v[60:63], v[20:35]
    v_exp_f32 v71, v39
    v_pk_add_f32 v[68:69], v[68:69], 1.0 op_sel_hi:[1,0]
    v_pk_add_f32 v[70:71], v[70:71], 1.0 op_sel_hi:[1,0]
    v_rcp_f32 v68, v68
    v_rcp_f32 v69, v69
    v_rcp_f32 v70, v70
    v_rcp_f32 v71, v71
    v_pk_mul_f32 v[36:37], v[36:37], v[68:69]
    v_pk_mul_f32 v[38:39], v[38:39], v[70:71]
    s_cmp_lt_u32 s13, 1
    s_cbranch_scc1 K_LB
    v_exp_f32 v72, v40
    v_exp_f32 v73, v41
    v_exp_f32 v74, v42
    v_exp_f32 v75, v43
    v_pk_add_f32 v[72:73], v[72:73], 1.0 op_sel_hi:[1,0]
    v_pk_add_f32 v[74:75], v[74:75], 1.0 op_sel_hi:[1,0]
    v_rcp_f32 v72, v72
    v_rcp_f32 v73, v73
    v_rcp_f32 v74, v74
    v_rcp_f32 v75, v75
    v_pk_mul_f32 v[40:41], v[40:41], v[72:73]
    v_pk_mul_f32 v[42:43], v[42:43], v[74:75]
    s_cmp_lt_u32 s13, 2
    s_cbranch_scc1 K_LB
    v_exp_f32 v76, v44
    v_exp_f32 v77, v45
    v_exp_f32 v78, v46
    v_exp_f32 v79, v47
    v_pk_add_f32 v[76:77], v[76:77], 1.0 op_sel_hi:[1,0]
    v_pk_add_f32 v[78:79], v[78:79], 1.0 op_sel_hi:[1,0]
    v_rcp_f32 v76, v76
    v_rcp_f32 v77, v77
    v_rcp_f32 v78, v78
    v_rcp_f32 v79, v79
    v_pk_mul_f32 v[44:45], v[44:45], v[76:77]
    v_pk_mul_f32 v[46:47], v[46:47], v[78:79]
    s_cmp_lt_u32 s13, 3
    s_cbranch_scc1 K_LB
    v_exp_f32 v80, v48
    v_exp_f32 v81, v49
    v_exp_f32 v82, v50
    v_exp_f32 v83, v51
    v_pk_add_f32 v[80:81], v[80:81], 1.0 op_sel_hi:[1,0]
    v_pk_add_f32 v[82:83], v[82:83], 1.0 op_sel_hi:[1,0]
    v_rcp_f32 v80, v80
    v_rcp_f32 v81, v81
    v_rcp_f32 v82, v82
    v_rcp_f32 v83, v83
    v_pk_mul_f32 v[48:49], v[48:49], v[80:81]
    v_pk_mul_f32 v[50:51], v[50:51], v[82:83]
K_LB:
    v_cvt_pk_bf16_f32 v36, v36, v37
    v_cvt_pk_bf16_f32 v37, v38, v39
    v_cvt_pk_bf16_f32 v38, v40, v41
    v_cvt_pk_bf16_f32 v39, v42, v43
    v_cvt_pk_bf16_f32 v44, v44, v45
    v_cvt_pk_bf16_f32 v45, v46, v47
    v_cvt_pk_bf16_f32 v46, v48, v49
    v_cvt_pk_bf16_f32 v47, v50, v51
K_DRAIN:
    s_setprio 0
    s_nop 0
    v_mfma_f32_32x32x16_bf16 v[4:19], v[144:147], v[36:39], v[4:19]
    v_mfma_f32_32x32x16_bf16 v[4:19], v[148:151], v[44:47], v[4:19]
K_DRAINED:
    s_cmp_lg_u32 s98, 0
    s_cbranch_scc1 K_SLOWNEXT
K_TAIL:
    s_waitcnt lgkmcnt(0)
    ds_read_b128 v[160:163], v238
    s_mov_b32 s91, 0xbf317218
    v_lshlrev_b32 v202, 16, v242
    v_and_b32 v203, 0xffff0000, v242
    v_mul_f32 v202, s91, v202
    v_mul_f32 v203, s91, v203
    v_mul_f32 v23, s91, v23
    v_mul_f32 v27, s91, v27
    v_mul_f32 v31, s91, v31
    v_mul_f32 v35, s91, v35
    v_mul_f32 v20, v203, v20
    v_mul_f32 v21, v203, v21
    v_mul_f32 v22, v203, v22
    v_mul_f32 v24, v203, v24
    v_mul_f32 v25, v203, v25
    v_mul_f32 v26, v203, v26
    v_mul_f32 v28, v203, v28
    v_mul_f32 v29, v203, v29
    v_mul_f32 v30, v203, v30
    v_mul_f32 v32, v203, v32
    v_mul_f32 v33, v203, v33
    v_mul_f32 v34, v203, v34
    v_mul_f32 v7, s91, v7
    v_cvt_pk_bf16_f32 v68, v7, v23
    ds_write_b32 v1, v68 offset:0
    v_mul_f32 v11, s91, v11
    v_cvt_pk_bf16_f32 v69, v11, v27
    ds_write_b32 v1, v69 offset:288
    v_mul_f32 v15, s91, v15
    v_cvt_pk_bf16_f32 v70, v15, v31
    ds_write_b32 v1, v70 offset:576
    v_mul_f32 v19, s91, v19
    v_cvt_pk_bf16_f32 v71, v19, v35
    ds_write_b32 v1, v71 offset:864
    ds_read_b128 v[68:71], v2 offset:0
    ds_read_b128 v[72:75], v2 offset:32
    ds_read_b128 v[76:79], v2 offset:64
    ds_read_b128 v[80:83], v2 offset:96
    v_pk_fma_f32 v[20:21], v[4:5], v[202:203], v[20:21] op_sel_hi:[1,0,1]
    v_fmac_f32 v22, v202, v6
    v_pk_fma_f32 v[24:25], v[8:9], v[202:203], v[24:25] op_sel_hi:[1,0,1]
    v_fmac_f32 v26, v202, v10
    v_pk_fma_f32 v[28:29], v[12:13], v[202:203], v[28:29] op_sel_hi:[1,0,1]
    v_fmac_f32 v30, v202, v14
    v_pk_fma_f32 v[32:33], v[16:17], v[202:203], v[32:33] op_sel_hi:[1,0,1]
    v_fmac_f32 v34, v202, v18
    v_permlane16_swap_b32 v20, v24
    v_permlane16_swap_b32 v21, v25
    v_permlane16_swap_b32 v22, v26
    v_permlane16_swap_b32 v28, v32
    v_permlane16_swap_b32 v29, v33
    v_permlane16_swap_b32 v30, v34
    s_waitcnt lgkmcnt(3)
    v_mfma_f32_32x32x16_bf16 v[36:51], v[68:71], v[168:171], 0
    v_add_f32 v20, v20, v24
    v_add_f32 v21, v21, v25
    v_add_f32 v22, v22, v26
    v_add_f32 v28, v28, v32
    v_add_f32 v29, v29, v33
    s_waitcnt lgkmcnt(2)
    v_mfma_f32_32x32x16_bf16 v[36:51], v[72:75], v[172:175], v[36:51]
    v_add_f32 v30, v30, v34
    v_add_f32_dpp v4, v20, v20 row_ror:8 row_mask:0xf bank_mask:0x3
    v_add_f32_dpp v5, v21, v21 row_ror:8 row_mask:0xf bank_mask:0x3
    v_add_f32_dpp v6, v22, v22 row_ror:8 row_mask:0xf bank_mask:0x3
    v_add_f32_dpp v4, v28, v28 row_ror:8 row_mask:0xf bank_mask:0xc
    s_waitcnt lgkmcnt(1)
    v_mfma_f32_32x32x16_bf16 v[36:51], v[76:79], v[176:179], v[36:51]
    v_add_f32_dpp v5, v29, v29 row_ror:8 row_mask:0xf bank_mask:0xc
    v_add_f32_dpp v6, v30, v30 row_ror:8 row_mask:0xf bank_mask:0xc
    v_add_f32_dpp v4, v4, v4 row_half_mirror row_mask:0xf bank_mask:0xf
    v_add_f32_dpp v5, v5, v5 row_half_mirror row_mask:0xf bank_mask:0xf
    v_add_f32_dpp v6, v6, v6 row_half_mirror row_mask:0xf bank_mask:0xf
    s_waitcnt lgkmcnt(0)
    v_mfma_f32_32x32x16_bf16 v[36:51], v[80:83], v[180:183], v[36:51]
    v_add_f32_dpp v4, v4, v4 quad_perm:[1,0,3,2] row_mask:0xf bank_mask:0xf
    v_add_f32_dpp v5, v5, v5 quad_perm:[1,0,3,2] row_mask:0xf bank_mask:0xf
    v_add_f32_dpp v6, v6, v6 quad_perm:[1,0,3,2] row_mask:0xf bank_mask:0xf
    v_add_f32_dpp v4, v4, v4 quad_perm:[2,3,0,1] row_mask:0xf bank_mask:0xf
    v_add_f32_dpp v5, v5, v5 quad_perm:[2,3,0,1] row_mask:0xf bank_mask:0xf
    v_mfma_f32_32x32x16_bf16 v[52:67], v[68:71], v[184:187], 0
    v_add_f32_dpp v6, v6, v6 quad_perm:[2,3,0,1] row_mask:0xf bank_mask:0xf
    v_cvt_pk_bf16_f32 v4, 0, v4
    v_cvt_pk_bf16_f32 v5, 0, v5
    v_cvt_pk_bf16_f32 v6, 0, v6
    v_add_f32 v4, v4, v160
    v_mfma_f32_32x32x16_bf16 v[52:67], v[72:75], v[188:191], v[52:67]
    v_add_f32 v5, v5, v161
    v_add_f32 v6, v6, v162
    v_cvt_pk_bf16_f32 v4, v4, v4
    v_cvt_pk_bf16_f32 v5, v5, v5
    v_cvt_pk_bf16_f32 v6, v6, v6
    v_mfma_f32_32x32x16_bf16 v[52:67], v[76:79], v[192:195], v[52:67]
    v_lshlrev_b32 v12, 16, v164
    v_and_b32 v164, 0xffff0000, v164
    v_lshlrev_b32 v13, 16, v165
    v_and_b32 v165, 0xffff0000, v165
    v_lshlrev_b32 v14, 16, v166
    v_mfma_f32_32x32x16_bf16 v[52:67], v[80:83], v[196:199], v[52:67]
    v_and_b32 v166, 0xffff0000, v166
    v_lshlrev_b32 v15, 16, v167
    v_and_b32 v167, 0xffff0000, v167
    s_mov_b32 exec_lo, 0x01010101
    s_mov_b32 exec_hi, 0x01010101
    buffer_store_short v4, v3, s[36:39], 0 offen offset:0
    buffer_store_short v5, v3, s[36:39], 0 offen offset:2
    buffer_store_short v6, v3, s[36:39], 0 offen offset:4
    s_mov_b64 exec, -1
    v_mov_b32 v202, s94
    v_pk_add_f32 v[36:37], v[36:37], v[152:153]
    v_pk_add_f32 v[38:39], v[38:39], v[154:155]
    v_cvt_pk_bf16_f32 v36, 0, v36
    v_cvt_pk_bf16_f32 v37, 0, v37
    v_cvt_pk_bf16_f32 v38, 0, v38
    v_cvt_pk_bf16_f32 v39, 0, v39
    v_pk_mul_f32 v[20:21], v[36:37], v[202:203] op_sel_hi:[1,0]
    v_pk_mul_f32 v[22:23], v[38:39], v[202:203] op_sel_hi:[1,0]
    v_exp_f32 v20, v20
    v_exp_f32 v21, v21
    v_exp_f32 v22, v22
    v_exp_f32 v23, v23
    v_pk_add_f32 v[20:21], v[20:21], 1.0 op_sel_hi:[1,0]
    v_pk_add_f32 v[22:23], v[22:23], 1.0 op_sel_hi:[1,0]
    v_rcp_f32 v20, v20
    v_rcp_f32 v21, v21
    v_rcp_f32 v22, v22
    v_rcp_f32 v23, v23
    v_pk_mul_f32 v[36:37], v[36:37], v[20:21]
    v_pk_mul_f32 v[38:39], v[38:39], v[22:23]
    v_cvt_pk_bf16_f32 v36, 0, v36
    v_cvt_pk_bf16_f32 v37, 0, v37
    v_cvt_pk_bf16_f32 v38, 0, v38
    v_cvt_pk_bf16_f32 v39, 0, v39
    v_pk_add_f32 v[36:37], v[36:37], v[12:13]
    v_pk_add_f32 v[38:39], v[38:39], v[14:15]
    v_pk_add_f32 v[52:53], v[52:53], v[156:157]
    v_pk_add_f32 v[54:55], v[54:55], v[158:159]
    v_cvt_pk_bf16_f32 v52, 0, v52
    v_cvt_pk_bf16_f32 v53, 0, v53
    v_cvt_pk_bf16_f32 v54, 0, v54
    v_cvt_pk_bf16_f32 v55, 0, v55
    v_pk_mul_f32 v[24:25], v[52:53], v[202:203] op_sel_hi:[1,0]
    v_pk_mul_f32 v[26:27], v[54:55], v[202:203] op_sel_hi:[1,0]
    v_exp_f32 v24, v24
    v_exp_f32 v25, v25
    v_exp_f32 v26, v26
    v_exp_f32 v27, v27
    v_pk_add_f32 v[24:25], v[24:25], 1.0 op_sel_hi:[1,0]
    v_pk_add_f32 v[26:27], v[26:27], 1.0 op_sel_hi:[1,0]
    v_rcp_f32 v24, v24
    v_rcp_f32 v25, v25
    v_rcp_f32 v26, v26
    v_rcp_f32 v27, v27
    v_pk_mul_f32 v[52:53], v[52:53], v[24:25]
    v_pk_mul_f32 v[54:55], v[54:55], v[26:27]
    v_cvt_pk_bf16_f32 v52, 0, v52
    v_cvt_pk_bf16_f32 v53, 0, v53
    v_cvt_pk_bf16_f32 v54, 0, v54
    v_cvt_pk_bf16_f32 v55, 0, v55
    v_pk_add_f32 v[52:53], v[52:53], v[164:165]
    v_pk_add_f32 v[54:55], v[54:55], v[166:167]
    s_mov_b32 s91, 0
    v_cvt_pk_bf16_f32 v36, v36, v52
    buffer_store_dword v36, v246, s[28:31], s91 offen
    s_mov_b32 s91, 262144
    v_cvt_pk_bf16_f32 v37, v37, v53
    buffer_store_dword v37, v246, s[28:31], s91 offen
    s_mov_b32 s91, 786432
    v_cvt_pk_bf16_f32 v39, v39, v55
    buffer_store_dword v39, v246, s[28:31], s91 offen
    s_mov_b32 s91, 524288
    v_cvt_pk_bf16_f32 v38, v38, v54
    s_mov_b32 exec_hi, s96
    buffer_store_dword v38, v247, s[28:31], s91 offen
K_END:
    s_endpgm
K_RETRY:
    s_add_u32 s86, s86, 1
    s_sleep 8
    buffer_load_ushort v100, v227, s[28:31], 0 offen sc1
    s_mov_b32 s91, 262144
    buffer_load_ushort v101, v227, s[28:31], s91 offen sc1
    s_mov_b32 s91, 524288
    buffer_load_ushort v102, v227, s[28:31], s91 offen sc1
    s_mov_b32 s91, 786432
    buffer_load_ushort v103, v227, s[28:31], s91 offen sc1
    s_mov_b32 s91, 1048576
    buffer_load_ushort v104, v227, s[28:31], s91 offen sc1
    s_mov_b32 s91, 1310720
    buffer_load_ushort v105, v227, s[28:31], s91 offen sc1
    s_mov_b32 s91, 1572864
    buffer_load_ushort v106, v227, s[28:31], s91 offen sc1
    s_mov_b32 s91, 1835008
    buffer_load_ushort v107, v227, s[28:31], s91 offen sc1
    s_cmp_lt_u32 s86, 0x100000
    s_waitcnt vmcnt(0)
    s_cbranch_scc1 K_POLL
    v_mov_b32 v224, 162912
    v_mov_b32 v221, 0x40000000
    ds_write_b32 v224, v221
    v_mov_b32 v100, 0
    v_mov_b32 v101, 0
    v_mov_b32 v102, 0
    v_mov_b32 v103, 0
    v_mov_b32 v104, 0
    v_mov_b32 v105, 0
    v_mov_b32 v106, 0
    v_mov_b32 v107, 0
    s_nop 1
    s_branch K_GOT
K_FRETRY:
    s_add_u32 s47, s47, 1
    s_cmp_gt_u32 s47, 0x100000
    s_cbranch_scc1 K_FOK
    s_sleep 8
    global_load_dwordx4 v[128:131], v249, s[32:33] sc1
    s_waitcnt vmcnt(0)
    s_branch K_FCHK
K_STUB:
    s_waitcnt lgkmcnt(0)
    buffer_load_dword v84, v84, s[24:27], 0 offen sc1
    buffer_load_dword v85, v85, s[24:27], 0 offen sc1
    buffer_load_dword v86, v86, s[24:27], 0 offen sc1
    buffer_load_dword v87, v87, s[24:27], 0 offen sc1
    buffer_load_dword v88, v88, s[24:27], 0 offen sc1
    buffer_load_dword v89, v89, s[24:27], 0 offen sc1
    buffer_load_dword v90, v90, s[24:27], 0 offen sc1
    buffer_load_dword v91, v91, s[24:27], 0 offen sc1
    buffer_load_dword v92, v92, s[24:27], 0 offen sc1
    buffer_load_dword v93, v93, s[24:27], 0 offen sc1
    buffer_load_dword v94, v94, s[24:27], 0 offen sc1
    buffer_load_dword v95, v95, s[24:27], 0 offen sc1
    buffer_load_dword v96, v96, s[24:27], 0 offen sc1
    buffer_load_dword v97, v97, s[24:27], 0 offen sc1
    buffer_load_dword v98, v98, s[24:27], 0 offen sc1
    buffer_load_dword v99, v99, s[24:27], 0 offen sc1
    buffer_load_dwordx4 v[136:139], v209, s[20:23], 0 offen
    s_branch K_NOSETUP
K_ONE:
    s_waitcnt vmcnt(0)
    s_nop 7
    s_branch K_LAST0
K_EMPTY:
    s_waitcnt vmcnt(0)
    s_nop 7
    s_branch K_DRAINED
K_SLOW0:
    v_readlane_b32 s91, v240, 10
    s_mov_b32 s98, 1
    s_cmp_lg_u32 s91, 0
    s_cbranch_scc1 K_END
    ds_bpermute_b32 v210, v212, v240
    ds_bpermute_b32 v211, v213, v240
    v_and_b32 v212, 56, v0
    s_waitcnt lgkmcnt(1)
    v_lshl_add_u32 v210, v210, 3, v214
    s_waitcnt lgkmcnt(0)
    v_lshl_add_u32 v211, v211, 3, v215
    v_cmp_gt_u32 vcc, v210, v211
    s_nop 1
    v_lshrrev_b64 v[212:213], v212, vcc
    v_and_b32 v212, 0xff, v212
    v_bcnt_u32_b32 v212, v212, 0
    v_cmp_eq_u32 vcc, s12, v212
    s_nop 0
    s_ff1_i32_b64 s12, vcc
    s_lshr_b32 s12, s12, 3
    s_lshl_b32 s95, s12, 8
    s_add_u32 s95, s95, s84
    v_cmp_eq_u32 vcc, 6, v1
    v_mov_b32 v225, s99
    v_lshl_add_u32 v221, v1, 11, s95
    v_readlane_b32 s85, v240, s12
    v_cndmask_b32 v221, v221, v225, vcc
    v_lshl_add_u32 v225, v221, 7, v233
    s_mul_i32 s93, s12, 2320
    v_lshl_add_u32 v152, v152, 2, v223
    v_cmp_lt_i32 s[52:53], 0, v160
    v_lshl_add_u32 v153, v153, 2, v223
    v_cmp_lt_i32 s[56:57], 0, v161
    v_lshl_add_u32 v154, v154, 2, v223
    v_cmp_lt_i32 s[60:61], 0, v162
    v_lshl_add_u32 v155, v155, 2, v223
    v_cmp_lt_i32 s[64:65], 0, v163
    v_lshl_add_u32 v156, v156, 2, v223
    v_cmp_lt_i32 s[68:69], 0, v164
    v_lshl_add_u32 v157, v157, 2, v223
    v_cmp_lt_i32 s[72:73], 0, v165
    v_lshl_add_u32 v158, v158, 2, v223
    v_cmp_lt_i32 s[76:77], 0, v166
    v_lshl_add_u32 v159, v159, 2, v223
    v_cmp_lt_i32 s[80:81], 0, v167
    v_mov_b32 v168, v132
    v_mov_b32 v176, v160
    v_mov_b32 v184, v152
    v_mov_b32 v169, v133
    v_mov_b32 v177, v161
    v_mov_b32 v185, v153
    v_mov_b32 v170, v134
    v_mov_b32 v178, v162
    v_mov_b32 v186, v154
    v_mov_b32 v171, v200
    v_mov_b32 v179, v163
    v_mov_b32 v187, v155
    v_mov_b32 v172, v136
    v_mov_b32 v180, v164
    v_mov_b32 v188, v156
    v_mov_b32 v173, v137
    v_mov_b32 v181, v165
    v_mov_b32 v189, v157
    v_mov_b32 v174, v138
    v_mov_b32 v182, v166
    v_mov_b32 v190, v158
    v_mov_b32 v175, v139
    v_mov_b32 v183, v167
    v_mov_b32 v191, v159
    v_mov_b32 v2, 0x6c0000
    v_mov_b32 v3, s47
    s_or_b32 s91, s2, s3
    s_cselect_b64 exec, 0, 1
    global_store_dword v2, v3, s[32:33] sc1
    s_mov_b32 exec_lo, 0x7f
    s_mov_b32 exec_hi, 0x7f
    buffer_load_dwordx4 v[144:147], v225, s[40:43], 0 offen offset:0
    buffer_load_dwordx4 v[148:151], v225, s[40:43], 0 offen offset:32
    buffer_load_dwordx4 v[140:143], v225, s[40:43], 0 offen offset:64
    buffer_load_dwordx4 v[124:127], v225, s[40:43], 0 offen offset:96
    s_mov_b64 exec, -1
    s_mov_b32 s47, 0
    global_load_dwordx4 v[128:131], v249, s[32:33] sc1
    s_mov_b64 s[20:21], s[8:9]
    s_mov_b32 s22, 0x186a000
    s_mov_b32 s23, 0x20000
    s_add_u32 s24, s32, 0x520000
    s_addc_u32 s25, s33, 0
    s_or_b32 s25, s25, 0x80000000
    s_mov_b32 s26, 0x186a00
    s_mov_b32 s27, 0xc00000
    s_waitcnt vmcnt(0) lgkmcnt(0)
    s_branch K_SLOWPLACE
K_SLOWNEXT:
    s_add_u32 s89, s89, 576
    v_cmp_lt_u32 vcc, s89, v240
    s_nop 0
    s_and_b32 s91, vcc_lo, 0xff
    s_cbranch_scc1 K_MORE
    s_waitcnt vmcnt(0) lgkmcnt(0)
    v_and_b32 v228, 31, v0
    v_lshlrev_b32 v228, 2, v228
    v_lshl_add_u32 v228, v233, 6, v228
    v_add_u32 v228, 12288, v228
    s_mov_b32 s61, 0x05040100
    s_mov_b32 s62, 0x07060302
    global_load_dword v84, v228, s[18:19] offset:-4096
    global_load_dword v85, v228, s[18:19] offset:-3968
    global_load_dword v86, v228, s[18:19] offset:-3840
    global_load_dword v87, v228, s[18:19] offset:-3712
    global_load_dword v88, v228, s[18:19] offset:-3584
    global_load_dword v89, v228, s[18:19] offset:-3456
    global_load_dword v90, v228, s[18:19] offset:-3328
    global_load_dword v91, v228, s[18:19] offset:-3200
    global_load_dword v92, v228, s[18:19] offset:-2048
    global_load_dword v93, v228, s[18:19] offset:-1920
    global_load_dword v94, v228, s[18:19] offset:-1792
    global_load_dword v95, v228, s[18:19] offset:-1664
    global_load_dword v96, v228, s[18:19] offset:-1536
    global_load_dword v97, v228, s[18:19] offset:-1408
    global_load_dword v98, v228, s[18:19] offset:-1280
    global_load_dword v99, v228, s[18:19] offset:-1152
    global_load_dword v100, v228, s[18:19] offset:0
    global_load_dword v101, v228, s[18:19] offset:128
    global_load_dword v102, v228, s[18:19] offset:256
    global_load_dword v103, v228, s[18:19] offset:384
    global_load_dword v104, v228, s[18:19] offset:512
    global_load_dword v105, v228, s[18:19] offset:640
    global_load_dword v106, v228, s[18:19] offset:768
    global_load_dword v107, v228, s[18:19] offset:896
    global_load_dword v108, v228, s[18:19] offset:2048
    global_load_dword v109, v228, s[18:19] offset:2176
    global_load_dword v110, v228, s[18:19] offset:2304
    global_load_dword v111, v228, s[18:19] offset:2432
    global_load_dword v112, v228, s[18:19] offset:2560
    global_load_dword v113, v228, s[18:19] offset:2688
    global_load_dword v114, v228, s[18:19] offset:2816
    global_load_dword v115, v228, s[18:19] offset:2944
    s_waitcnt vmcnt(30)
    v_perm_b32 v168, v85, v84, s61
    v_perm_b32 v184, v85, v84, s62
    s_waitcnt vmcnt(28)
    v_perm_b32 v169, v87, v86, s61
    v_perm_b32 v185, v87, v86, s62
    s_waitcnt vmcnt(26)
    v_perm_b32 v170, v89, v88, s61
    v_perm_b32 v186, v89, v88, s62
    s_waitcnt vmcnt(24)
    v_perm_b32 v171, v91, v90, s61
    v_perm_b32 v187, v91, v90, s62
    s_waitcnt vmcnt(22)
    v_perm_b32 v172, v93, v92, s61
    v_perm_b32 v188, v93, v92, s62
    s_waitcnt vmcnt(20)
    v_perm_b32 v173, v95, v94, s61
    v_perm_b32 v189, v95, v94, s62
    s_waitcnt vmcnt(18)
    v_perm_b32 v174, v97, v96, s61
    v_perm_b32 v190, v97, v96, s62
    s_waitcnt vmcnt(16)
    v_perm_b32 v175, v99, v98, s61
    v_perm_b32 v191, v99, v98, s62
    s_waitcnt vmcnt(14)
    v_perm_b32 v176, v101, v100, s61
    v_perm_b32 v192, v101, v100, s62
    s_waitcnt vmcnt(12)
    v_perm_b32 v177, v103, v102, s61
    v_perm_b32 v193, v103, v102, s62
    s_waitcnt vmcnt(10)
    v_perm_b32 v178, v105, v104, s61
    v_perm_b32 v194, v105, v104, s62
    s_waitcnt vmcnt(8)
    v_perm_b32 v179, v107, v106, s61
    v_perm_b32 v195, v107, v106, s62
    s_waitcnt vmcnt(6)
    v_perm_b32 v180, v109, v108, s61
    v_perm_b32 v196, v109, v108, s62
    s_waitcnt vmcnt(4)
    v_perm_b32 v181, v111, v110, s61
    v_perm_b32 v197, v111, v110, s62
    s_waitcnt vmcnt(2)
    v_perm_b32 v182, v113, v112, s61
    v_perm_b32 v198, v113, v112, s62
    s_waitcnt vmcnt(0)
    v_perm_b32 v183, v115, v114, s61
    v_perm_b32 v199, v115, v114, s62
    s_branch K_TAIL
K_MORE:
    s_waitcnt vmcnt(0) lgkmcnt(0)
    s_barrier
    v_mov_b32 v68, 0
    v_mov_b32 v69, 0
    v_mov_b32 v70, 0
    v_mov_b32 v71, 0
    ds_write_b128 v237, v[68:71]
    ds_write_b128 v237, v[68:71] offset:16
    ds_write_b128 v237, v[68:71] offset:32
    ds_write_b128 v237, v[68:71] offset:48
    ds_write_b128 v236, v[68:71]
    ds_write_b128 v236, v[68:71] offset:16
K_SLOWPLACE:
    v_readlane_b32 s85, v240, s12
    s_nop 1
    s_max_u32 s85, s85, s89
    s_sub_u32 s85, s85, s89
    s_min_u32 s85, s85, 576
    s_mov_b32 s91, 516
    v_add_u32 v1, s85, v0
    v_mov_b32 v2, 50000
    v_mov_b32 v3, 0x7ffffffc
    v_cmp_gt_u32 vcc, 580, v1
    v_cmp_gt_u32 s[100:101], s91, v1
    v_lshl_add_u32 v1, v1, 2, s93
    s_mov_b64 exec, vcc
    ds_write2st64_b32 v1, v2, v3 offset0:0 offset1:74
    s_mov_b64 exec, s[100:101]
    ds_write2st64_b32 v1, v2, v3 offset0:1 offset1:75
    s_mov_b64 exec, -1
    s_lshl_b32 s59, s89, 2
    s_mov_b32 s60, 2320
    s_mov_b32 s63, 2304
    v_and_b32 v77, 15, v0
    v_mov_b32 v76, s90
    v_cmp_eq_u32 vcc, 8, v77
    s_mov_b32 s64, 2367
    s_mov_b32 s66, 0x01ff01ff
    s_mov_b32 s67, 0x01ff01ff
    v_cndmask_b32 v76, v77, v76, vcc
    v_mul_lo_u32 v76, v76, s60
    v_lshl_add_u32 v76, v77, 2, v76
    v_add_u32 v76, s59, v76
    v_subrev_u32 v76, 63, v76
    s_mov_b32 s56, 0
    s_mov_b32 s57, 0
    s_mov_b32 s58, 0
K_SL0:
    v_cmp_lt_i32 vcc, s56, v176
    s_cbranch_vccz K_SLD0
    s_mov_b64 s[52:53], vcc
    s_lshl_b32 s91, s56, 2
    v_add_u32 v68, s91, v168
    v_sub_u32 v69, v184, v76
    v_add_u32 v69, v69, v68
    s_add_u32 s56, s56, 16
    v_cmp_gt_u32 vcc, s64, v69
    s_nop 0
    s_and_b64 vcc, vcc, s[66:67]
    s_cbranch_scc0 K_SL0
    v_mov_b32 v69, 0
    s_mov_b64 exec, s[52:53]
    buffer_load_dword v69, v68, s[32:35], s57 offen sc1
    s_mov_b64 exec, -1
    s_waitcnt vmcnt(0)
    v_bfe_u32 v70, v69, 14, 6
    v_and_b32 v71, 7, v70
    v_subrev_u32 v70, 40, v70
    v_max_i32 v70, v70, v71
    v_lshl_add_u32 v71, v70, 2, v244
    ds_bpermute_b32 v71, v71, v184
    v_mov_b32 v74, s90
    v_cmp_eq_u32 vcc, 8, v70
    s_nop 1
    v_cndmask_b32 v70, v70, v74, vcc
    v_mul_lo_u32 v70, v70, s60
    v_lshrrev_b32 v73, 15, v69
    v_lshlrev_b16 v72, 2, v69
    v_add3_u32 v73, v73, v243, s58
    s_waitcnt lgkmcnt(0)
    v_add_u32 v71, v71, v68
    v_subrev_u32 v71, s59, v71
    v_sub_u32 v70, v71, v70
    v_cmp_gt_u32 vcc, s63, v70
    s_nop 0
    s_and_b64 exec, vcc, s[52:53]
    ds_write2st64_b32 v71, v72, v73 offset0:0 offset1:74
    s_mov_b64 exec, -1
    s_branch K_SL0
K_SLD0:
    s_mov_b32 s56, 0
    s_mov_b32 s57, 409600
    s_mov_b32 s58, 3276800
K_SL1:
    v_cmp_lt_i32 vcc, s56, v177
    s_cbranch_vccz K_SLD1
    s_mov_b64 s[52:53], vcc
    s_lshl_b32 s91, s56, 2
    v_add_u32 v68, s91, v169
    v_sub_u32 v69, v185, v76
    v_add_u32 v69, v69, v68
    s_add_u32 s56, s56, 16
    v_cmp_gt_u32 vcc, s64, v69
    s_nop 0
    s_and_b64 vcc, vcc, s[66:67]
    s_cbranch_scc0 K_SL1
    v_mov_b32 v69, 0
    s_mov_b64 exec, s[52:53]
    buffer_load_dword v69, v68, s[32:35], s57 offen sc1
    s_mov_b64 exec, -1
    s_waitcnt vmcnt(0)
    v_bfe_u32 v70, v69, 14, 6
    v_and_b32 v71, 7, v70
    v_subrev_u32 v70, 40, v70
    v_max_i32 v70, v70, v71
    v_lshl_add_u32 v71, v70, 2, v244
    ds_bpermute_b32 v71, v71, v185
    v_mov_b32 v74, s90
    v_cmp_eq_u32 vcc, 8, v70
    s_nop 1
    v_cndmask_b32 v70, v70, v74, vcc
    v_mul_lo_u32 v70, v70, s60
    v_lshrrev_b32 v73, 15, v69
    v_lshlrev_b16 v72, 2, v69
    v_add3_u32 v73, v73, v243, s58
    s_waitcnt lgkmcnt(0)
    v_add_u32 v71, v71, v68
    v_subrev_u32 v71, s59, v71
    v_sub_u32 v70, v71, v70
    v_cmp_gt_u32 vcc, s63, v70
    s_nop 0
    s_and_b64 exec, vcc, s[52:53]
    ds_write2st64_b32 v71, v72, v73 offset0:0 offset1:74
    s_mov_b64 exec, -1
    s_branch K_SL1
K_SLD1:
    s_mov_b32 s56, 0
    s_mov_b32 s57, 819200
    s_mov_b32 s58, 6553600
K_SL2:
    v_cmp_lt_i32 vcc, s56, v178
    s_cbranch_vccz K_SLD2
    s_mov_b64 s[52:53], vcc
    s_lshl_b32 s91, s56, 2
    v_add_u32 v68, s91, v170
    v_sub_u32 v69, v186, v76
    v_add_u32 v69, v69, v68
    s_add_u32 s56, s56, 16
    v_cmp_gt_u32 vcc, s64, v69
    s_nop 0
    s_and_b64 vcc, vcc, s[66:67]
    s_cbranch_scc0 K_SL2
    v_mov_b32 v69, 0
    s_mov_b64 exec, s[52:53]
    buffer_load_dword v69, v68, s[32:35], s57 offen sc1
    s_mov_b64 exec, -1
    s_waitcnt vmcnt(0)
    v_bfe_u32 v70, v69, 14, 6
    v_and_b32 v71, 7, v70
    v_subrev_u32 v70, 40, v70
    v_max_i32 v70, v70, v71
    v_lshl_add_u32 v71, v70, 2, v244
    ds_bpermute_b32 v71, v71, v186
    v_mov_b32 v74, s90
    v_cmp_eq_u32 vcc, 8, v70
    s_nop 1
    v_cndmask_b32 v70, v70, v74, vcc
    v_mul_lo_u32 v70, v70, s60
    v_lshrrev_b32 v73, 15, v69
    v_lshlrev_b16 v72, 2, v69
    v_add3_u32 v73, v73, v243, s58
    s_waitcnt lgkmcnt(0)
    v_add_u32 v71, v71, v68
    v_subrev_u32 v71, s59, v71
    v_sub_u32 v70, v71, v70
    v_cmp_gt_u32 vcc, s63, v70
    s_nop 0
    s_and_b64 exec, vcc, s[52:53]
    ds_write2st64_b32 v71, v72, v73 offset0:0 offset1:74
    s_mov_b64 exec, -1
    s_branch K_SL2
K_SLD2:
    s_mov_b32 s56, 0
    s_mov_b32 s57, 1228800
    s_mov_b32 s58, 9830400
K_SL3:
    v_cmp_lt_i32 vcc, s56, v179
    s_cbranch_vccz K_SLD3
    s_mov_b64 s[52:53], vcc
    s_lshl_b32 s91, s56, 2
    v_add_u32 v68, s91, v171
    v_sub_u32 v69, v187, v76
    v_add_u32 v69, v69, v68
    s_add_u32 s56, s56, 16
    v_cmp_gt_u32 vcc, s64, v69
    s_nop 0
    s_and_b64 vcc, vcc, s[66:67]
    s_cbranch_scc0 K_SL3
    v_mov_b32 v69, 0
    s_mov_b64 exec, s[52:53]
    buffer_load_dword v69, v68, s[32:35], s57 offen sc1
    s_mov_b64 exec, -1
    s_waitcnt vmcnt(0)
    v_bfe_u32 v70, v69, 14, 6
    v_and_b32 v71, 7, v70
    v_subrev_u32 v70, 40, v70
    v_max_i32 v70, v70, v71
    v_lshl_add_u32 v71, v70, 2, v244
    ds_bpermute_b32 v71, v71, v187
    v_mov_b32 v74, s90
    v_cmp_eq_u32 vcc, 8, v70
    s_nop 1
    v_cndmask_b32 v70, v70, v74, vcc
    v_mul_lo_u32 v70, v70, s60
    v_lshrrev_b32 v73, 15, v69
    v_lshlrev_b16 v72, 2, v69
    v_add3_u32 v73, v73, v243, s58
    s_waitcnt lgkmcnt(0)
    v_add_u32 v71, v71, v68
    v_subrev_u32 v71, s59, v71
    v_sub_u32 v70, v71, v70
    v_cmp_gt_u32 vcc, s63, v70
    s_nop 0
    s_and_b64 exec, vcc, s[52:53]
    ds_write2st64_b32 v71, v72, v73 offset0:0 offset1:74
    s_mov_b64 exec, -1
    s_branch K_SL3
K_SLD3:
    s_mov_b32 s56, 0
    s_mov_b32 s57, 1638400
    s_mov_b32 s58, 13107200
K_SL4:
    v_cmp_lt_i32 vcc, s56, v180
    s_cbranch_vccz K_SLD4
    s_mov_b64 s[52:53], vcc
    s_lshl_b32 s91, s56, 2
    v_add_u32 v68, s91, v172
    v_sub_u32 v69, v188, v76
    v_add_u32 v69, v69, v68
    s_add_u32 s56, s56, 16
    v_cmp_gt_u32 vcc, s64, v69
    s_nop 0
    s_and_b64 vcc, vcc, s[66:67]
    s_cbranch_scc0 K_SL4
    v_mov_b32 v69, 0
    s_mov_b64 exec, s[52:53]
    buffer_load_dword v69, v68, s[32:35], s57 offen sc1
    s_mov_b64 exec, -1
    s_waitcnt vmcnt(0)
    v_bfe_u32 v70, v69, 14, 6
    v_and_b32 v71, 7, v70
    v_subrev_u32 v70, 40, v70
    v_max_i32 v70, v70, v71
    v_lshl_add_u32 v71, v70, 2, v244
    ds_bpermute_b32 v71, v71, v188
    v_mov_b32 v74, s90
    v_cmp_eq_u32 vcc, 8, v70
    s_nop 1
    v_cndmask_b32 v70, v70, v74, vcc
    v_mul_lo_u32 v70, v70, s60
    v_lshrrev_b32 v73, 15, v69
    v_lshlrev_b16 v72, 2, v69
    v_add3_u32 v73, v73, v243, s58
    s_waitcnt lgkmcnt(0)
    v_add_u32 v71, v71, v68
    v_subrev_u32 v71, s59, v71
    v_sub_u32 v70, v71, v70
    v_cmp_gt_u32 vcc, s63, v70
    s_nop 0
    s_and_b64 exec, vcc, s[52:53]
    ds_write2st64_b32 v71, v72, v73 offset0:0 offset1:74
    s_mov_b64 exec, -1
    s_branch K_SL4
K_SLD4:
    s_mov_b32 s56, 0
    s_mov_b32 s57, 2048000
    s_mov_b32 s58, 16384000
K_SL5:
    v_cmp_lt_i32 vcc, s56, v181
    s_cbranch_vccz K_SLD5
    s_mov_b64 s[52:53], vcc
    s_lshl_b32 s91, s56, 2
    v_add_u32 v68, s91, v173
    v_sub_u32 v69, v189, v76
    v_add_u32 v69, v69, v68
    s_add_u32 s56, s56, 16
    v_cmp_gt_u32 vcc, s64, v69
    s_nop 0
    s_and_b64 vcc, vcc, s[66:67]
    s_cbranch_scc0 K_SL5
    v_mov_b32 v69, 0
    s_mov_b64 exec, s[52:53]
    buffer_load_dword v69, v68, s[32:35], s57 offen sc1
    s_mov_b64 exec, -1
    s_waitcnt vmcnt(0)
    v_bfe_u32 v70, v69, 14, 6
    v_and_b32 v71, 7, v70
    v_subrev_u32 v70, 40, v70
    v_max_i32 v70, v70, v71
    v_lshl_add_u32 v71, v70, 2, v244
    ds_bpermute_b32 v71, v71, v189
    v_mov_b32 v74, s90
    v_cmp_eq_u32 vcc, 8, v70
    s_nop 1
    v_cndmask_b32 v70, v70, v74, vcc
    v_mul_lo_u32 v70, v70, s60
    v_lshrrev_b32 v73, 15, v69
    v_lshlrev_b16 v72, 2, v69
    v_add3_u32 v73, v73, v243, s58
    s_waitcnt lgkmcnt(0)
    v_add_u32 v71, v71, v68
    v_subrev_u32 v71, s59, v71
    v_sub_u32 v70, v71, v70
    v_cmp_gt_u32 vcc, s63, v70
    s_nop 0
    s_and_b64 exec, vcc, s[52:53]
    ds_write2st64_b32 v71, v72, v73 offset0:0 offset1:74
    s_mov_b64 exec, -1
    s_branch K_SL5
K_SLD5:
    s_mov_b32 s56, 0
    s_mov_b32 s57, 2457600
    s_mov_b32 s58, 19660800
K_SL6:
    v_cmp_lt_i32 vcc, s56, v182
    s_cbranch_vccz K_SLD6
    s_mov_b64 s[52:53], vcc
    s_lshl_b32 s91, s56, 2
    v_add_u32 v68, s91, v174
    v_sub_u32 v69, v190, v76
    v_add_u32 v69, v69, v68
    s_add_u32 s56, s56, 16
    v_cmp_gt_u32 vcc, s64, v69
    s_nop 0
    s_and_b64 vcc, vcc, s[66:67]
    s_cbranch_scc0 K_SL6
    v_mov_b32 v69, 0
    s_mov_b64 exec, s[52:53]
    buffer_load_dword v69, v68, s[32:35], s57 offen sc1
    s_mov_b64 exec, -1
    s_waitcnt vmcnt(0)
    v_bfe_u32 v70, v69, 14, 6
    v_and_b32 v71, 7, v70
    v_subrev_u32 v70, 40, v70
    v_max_i32 v70, v70, v71
    v_lshl_add_u32 v71, v70, 2, v244
    ds_bpermute_b32 v71, v71, v190
    v_mov_b32 v74, s90
    v_cmp_eq_u32 vcc, 8, v70
    s_nop 1
    v_cndmask_b32 v70, v70, v74, vcc
    v_mul_lo_u32 v70, v70, s60
    v_lshrrev_b32 v73, 15, v69
    v_lshlrev_b16 v72, 2, v69
    v_add3_u32 v73, v73, v243, s58
    s_waitcnt lgkmcnt(0)
    v_add_u32 v71, v71, v68
    v_subrev_u32 v71, s59, v71
    v_sub_u32 v70, v71, v70
    v_cmp_gt_u32 vcc, s63, v70
    s_nop 0
    s_and_b64 exec, vcc, s[52:53]
    ds_write2st64_b32 v71, v72, v73 offset0:0 offset1:74
    s_mov_b64 exec, -1
    s_branch K_SL6
K_SLD6:
    s_mov_b32 s56, 0
    s_mov_b32 s57, 2867200
    s_mov_b32 s58, 22937600
K_SL7:
    v_cmp_lt_i32 vcc, s56, v183
    s_cbranch_vccz K_SLD7
    s_mov_b64 s[52:53], vcc
    s_lshl_b32 s91, s56, 2
    v_add_u32 v68, s91, v175
    v_sub_u32 v69, v191, v76
    v_add_u32 v69, v69, v68
    s_add_u32 s56, s56, 16
    v_cmp_gt_u32 vcc, s64, v69
    s_nop 0
    s_and_b64 vcc, vcc, s[66:67]
    s_cbranch_scc0 K_SL7
    v_mov_b32 v69, 0
    s_mov_b64 exec, s[52:53]
    buffer_load_dword v69, v68, s[32:35], s57 offen sc1
    s_mov_b64 exec, -1
    s_waitcnt vmcnt(0)
    v_bfe_u32 v70, v69, 14, 6
    v_and_b32 v71, 7, v70
    v_subrev_u32 v70, 40, v70
    v_max_i32 v70, v70, v71
    v_lshl_add_u32 v71, v70, 2, v244
    ds_bpermute_b32 v71, v71, v191
    v_mov_b32 v74, s90
    v_cmp_eq_u32 vcc, 8, v70
    s_nop 1
    v_cndmask_b32 v70, v70, v74, vcc
    v_mul_lo_u32 v70, v70, s60
    v_lshrrev_b32 v73, 15, v69
    v_lshlrev_b16 v72, 2, v69
    v_add3_u32 v73, v73, v243, s58
    s_waitcnt lgkmcnt(0)
    v_add_u32 v71, v71, v68
    v_subrev_u32 v71, s59, v71
    v_sub_u32 v70, v71, v70
    v_cmp_gt_u32 vcc, s63, v70
    s_nop 0
    s_and_b64 exec, vcc, s[52:53]
    ds_write2st64_b32 v71, v72, v73 offset0:0 offset1:74
    s_mov_b64 exec, -1
    s_branch K_SL7
K_SLD7:
    s_waitcnt vmcnt(0) lgkmcnt(0)
    s_barrier
    v_lshl_add_u32 v232, v0, 2, s93
    v_add_u32 v231, s93, v233
    ds_read2st64_b32 v[202:203], v232 offset0:0 offset1:74
    s_waitcnt lgkmcnt(0)
    v_and_b32 v208, s88, v203
    v_or_b32 v209, 16, v208
    s_nop 1
    v_permlane32_swap_b32 v208, v209
    buffer_load_dwordx4 v[132:135], v208, s[20:23], 0 offen
    s_branch K_JOIN

.section .rodata,"a"
.p2align 6
.amdhsa_kernel standalone__cheap_equivariant_egnn__graph_kernel
  .amdhsa_next_free_vgpr 252
  .amdhsa_next_free_sgpr 102
  .amdhsa_accum_offset 252
  .amdhsa_group_segment_fixed_size 0
  .amdhsa_kernarg_size 88
  .amdhsa_user_sgpr_count 2
  .amdhsa_user_sgpr_kernarg_segment_ptr 1
  .amdhsa_system_sgpr_workgroup_id_x 1
.end_amdhsa_kernel
```
